```python
import torch

def _softmax(x, axis=-1):
    return torch.softmax(x, dim=axis)
def _gelu(x):
    return torch.nn.functional.gelu(x, approximate="tanh")
def _silu(x):
    return torch.nn.functional.silu(x)
def _sigmoid(x):
    return torch.sigmoid(x)
def _layernorm(x, axis=-1, eps=1e-5):
    m = x.mean(dim=axis, keepdim=True)
    v = x.var(dim=axis, keepdim=True, unbiased=False)
    return (x - m) / torch.sqrt(v + eps)
def _scatter_add(tgt, idx, src, axis=0):
    return tgt.clone().index_add_(axis, idx, src)
def _segment_sum(src, seg, n):
    out = torch.zeros((n,) + src.shape[1:], dtype=src.dtype)
    return out.index_add_(0, seg, src)
def _pad(x, pw):
    flat = tuple(v for pair in reversed(pw) for v in pair)
    return torch.nn.functional.pad(x, flat)

kernel_name = 'parallel_sum__sliding_local_dilated__mixer_channel_mlp__prompt'

def setup_inputs():

    _w = (lambda a: (lambda t: t.to(torch.bfloat16) if t.is_floating_point() else t)(torch.as_tensor(a)))
    def _A_setup():
        B, S, D = 1, 2048, 640
        return {
            "x": _w((lambda *s: torch.randn(*s, dtype=torch.bfloat16) * 0.05)(B, S, D)),
            "wqkv": _w((lambda *s: torch.randn(*s, dtype=torch.bfloat16) * 0.05)(D, 3 * D)),
            "wo": _w((lambda *s: torch.randn(*s, dtype=torch.bfloat16) * 0.05)(D, D)),
        }
    _A_in = _A_setup()

    def _B_setup():
        B, S, D, F = 1, 2048, 640, 1728
        return {
            "x": _w((lambda *s: torch.randn(*s, dtype=torch.bfloat16) * 0.05)(B, S, D)),
            "w1": _w((lambda *s: torch.randn(*s, dtype=torch.bfloat16) * 3.2)(D, F) * (D ** -0.5)),
            "b1": _w((lambda *s: torch.randn(*s, dtype=torch.bfloat16) * 1.6)(F)),
            "w2": _w((lambda *s: torch.randn(*s, dtype=torch.bfloat16) * 0.2)(F, D) * (F ** -0.5)),
            "b2": _w((lambda *s: torch.randn(*s, dtype=torch.bfloat16) * 0.4)(D)),
        }
    _B_in = _B_setup()

    return {
        "A_x": _A_in["x"],
        "A_wqkv": _A_in["wqkv"],
        "A_wo": _A_in["wo"],
        "B_x": _B_in["x"],
        "B_w1": _B_in["w1"],
        "B_b1": _B_in["b1"],
        "B_w2": _B_in["w2"],
        "B_b2": _B_in["b2"],
    }

def reference(A_x, A_wqkv, A_wo, B_x, B_w1, B_b1, B_w2, B_b2):
    def _A_ref(x, wqkv, wo):
        B, S, D = x.shape
        H = 32; Dh = D // H
        W, dil = 8, 2
        qkv = (lambda x, *d: x.permute(*d))((x @ wqkv).reshape(B, S, 3, H, Dh), 2, 0, 3, 1, 4)
        q, k, v = qkv[0], qkv[1], qkv[2]
        scale = Dh ** -0.5
        pos = torch.arange(S)
        off = torch.arange(W) * dil
        idx = pos[:, None] - off[None, :]
        mask = idx >= 0
        idx_c = torch.where(mask, idx, 0).reshape(-1)
        kg = k[:, :, idx_c, :].reshape(B, H, S, W, Dh)
        vg = v[:, :, idx_c, :].reshape(B, H, S, W, Dh)
        logits = torch.einsum("bhsd,bhswd->bhsw", q, kg) * scale
        logits = torch.where(mask[None, None, :, :], logits, -1e9)
        attn = _softmax(logits, axis=-1)
        o = torch.einsum("bhsw,bhswd->bhsd", attn, vg)
        return (lambda x, *d: x.permute(*d))(o, 0, 2, 1, 3).reshape(B, S, D) @ wo

    def _B_ref(x, w1, b1, w2, b2):
        y = _layernorm(x, axis=-1)
        h = _gelu(torch.einsum("bsd,df->bsf", y, w1) + b1)
        return torch.einsum("bsf,fd->bsd", h, w2) + b2

    x = A_x
    xn = _layernorm(x, axis=-1)
    return x + _A_ref(xn, A_wqkv, A_wo) + _B_ref(xn, B_w1, B_b1, B_w2, B_b2)
```

```asm
; @launch grid=(256,1,1) block=(256,1,1) lds=163840
.amdgcn_target "amdgcn-amd-amdhsa--gfx950"
.text
.globl parallel_sum__sliding_local_dilated__mixer_channel_mlp__prompt_kernel
.p2align 8
.type parallel_sum__sliding_local_dilated__mixer_channel_mlp__prompt_kernel,@function
parallel_sum__sliding_local_dilated__mixer_channel_mlp__prompt_kernel:
    s_load_dwordx8 s[56:63], s[0:1], 0
    s_load_dwordx8 s[64:71], s[0:1], 32
    s_load_dwordx4 s[72:75], s[0:1], 64
    s_load_dwordx2 s[76:77], s[0:1], 80
    s_memrealtime s[100:101]
    s_cmp_ge_u32 s2, 256
    s_cbranch_scc1 L1_end
    s_and_b32 s37, s2, 7
    s_lshr_b32 s38, s2, 3
    v_and_b32 v1, 63, v0
    v_lshrrev_b32 v2, 6, v0
    s_nop 0
    v_readfirstlane_b32 s36, v2
    s_cmp_lt_u32 s38, 18
    s_cbranch_scc0 L1_mlpmap
    s_and_b32 s47, s37, 1
    s_mul_i32 s47, s47, 9
    s_lshr_b32 s39, s38, 1
    s_add_u32 s39, s39, s47
    s_lshr_b32 s47, s37, 1
    s_lshl_b32 s47, s47, 1
    s_and_b32 s40, s38, 1
    s_add_u32 s40, s40, s47
    s_mul_i32 s41, s39, 114
    s_mov_b32 s42, 1
    s_mov_b32 s51, s40
    s_mov_b32 s53, 128
    s_branch L1_mapdone
L1_mlpmap:
    s_sub_u32 s48, s38, 18

    s_lshr_b32 s47, s37, 1
    s_mul_i32 s47, s47, 14
    s_add_u32 s47, s47, s48
    s_lshr_b32 s40, s47, 3
    s_and_b32 s39, s47, 7
    s_and_b32 s47, s37, 1
    s_lshl_b32 s47, s47, 3
    s_add_u32 s39, s39, s47
    s_lshl_b32 s41, s39, 7
    s_mov_b32 s42, 0
    s_add_u32 s51, s40, 8
    s_mov_b32 s53, 128
    s_cmp_eq_u32 s40, 6
    s_cselect_b32 s53, 96, s53
L1_mapdone:
    s_add_u32 s44, s39, s40
    s_mul_i32 s47, s44, 205
    s_lshr_b32 s47, s47, 11
    s_mul_i32 s47, s47, 10
    s_sub_u32 s44, s44, s47
    s_lshl_b32 s46, s44, 7
    s_lshl_b32 s55, s36, 12
    v_lshrrev_b32 v52, 3, v1
    s_lshl_b32 s47, s36, 5
    s_add_u32 s47, s47, s41
    v_add_u32 v52, s47, v52
    v_mul_u32_u24 v52, 1280, v52
    v_and_b32 v53, 7, v1
    v_lshrrev_b32 v54, 4, v1
    v_xor_b32 v53, v53, v54
    v_lshlrev_b32 v53, 4, v53
    v_add_u32 v10, v52, v53
    v_xor_b32 v53, 64, v53
    v_add_u32 v11, v52, v53
    v_add_u32 v11, 10240, v11
    v_add_u32 v12, 20480, v10
    v_add_u32 v13, 20480, v11
    s_waitcnt lgkmcnt(0)
    s_mov_b32 s4, s56
    s_mov_b32 s5, s57
    s_mov_b32 s6, 2621440
    s_mov_b32 s7, 0x20000
    s_add_u32 m0, s55, 32768
    s_nop 0
    buffer_load_dwordx4 v10, s[4:7], s46 offen lds
    s_add_u32 m0, s55, 33792
    s_nop 0
    buffer_load_dwordx4 v11, s[4:7], s46 offen lds
    s_add_u32 m0, s55, 34816
    s_nop 0
    buffer_load_dwordx4 v12, s[4:7], s46 offen lds
    s_add_u32 m0, s55, 35840
    s_nop 0
    buffer_load_dwordx4 v13, s[4:7], s46 offen lds
    s_cmp_lt_u32 s39, 10
    s_cselect_b32 s37, 0, 1073741824
    s_cmp_eq_u32 s42, 1
    s_mov_b32 s47, 3456
    s_cselect_b32 s43, 3840, s47
    s_cselect_b32 s8, s58, s64
    s_cselect_b32 s9, s59, s65
    s_mov_b32 s47, 2211840
    s_cselect_b32 s10, 2457600, s47
    s_mov_b32 s11, 0x20000
    s_lshl_b32 s54, s36, 13
    s_mul_i32 s45, s44, s43
    s_lshl_b32 s45, s45, 6
    v_lshrrev_b32 v52, 5, v1
    v_bfe_u32 v53, v1, 4, 1
    v_and_b32 v54, 15, v1
    v_lshlrev_b32 v55, 2, v52
    v_lshl_or_b32 v55, v53, 1, v55
    v_xor_b32 v54, v54, v55
    v_xor_b32 v55, 8, v54
    s_lshl_b32 s47, s36, 4
    v_add_u32 v52, s47, v52
    v_mul_lo_u32 v52, v52, s43
    s_cmp_eq_u32 s42, 1
    s_cbranch_scc0 L1_wmlp
    s_mul_i32 s47, s40, 160
    v_mul_u32_u24 v53, 80, v53
    v_add_u32 v53, s47, v53
    v_mul_u32_u24 v56, 205, v54
    v_lshrrev_b32 v56, 10, v56
    v_mul_u32_u24 v56, 1200, v56
    v_cmp_eq_u32 vcc, 15, v54
    v_lshl_add_u32 v54, v54, 4, v56
    v_add_u32 v54, v54, v53
    v_mov_b32 v56, 1073741824
    v_cndmask_b32 v54, v54, v56, vcc
    v_mul_u32_u24 v56, 205, v55
    v_lshrrev_b32 v56, 10, v56
    v_mul_u32_u24 v56, 1200, v56
    v_cmp_eq_u32 vcc, 15, v55
    v_lshl_add_u32 v55, v55, 4, v56
    v_add_u32 v55, v55, v53
    v_mov_b32 v56, 1073741824
    v_cndmask_b32 v55, v55, v56, vcc
    s_branch L1_wdone
L1_wmlp:
    s_lshl_b32 s47, s40, 9
    s_lshl_b32 s48, s53, 1
    v_mul_u32_u24 v53, s48, v53
    v_add_u32 v53, s47, v53
    v_lshlrev_b32 v54, 4, v54
    v_cmp_le_u32 vcc, s48, v54
    v_add_u32 v54, v54, v53
    v_mov_b32 v56, 1073741824
    v_cndmask_b32 v54, v54, v56, vcc
    v_lshlrev_b32 v55, 4, v55
    v_cmp_le_u32 vcc, s48, v55
    v_add_u32 v55, v55, v53
    v_mov_b32 v56, 1073741824
    v_cndmask_b32 v55, v55, v56, vcc
L1_wdone:
    v_add_u32 v2, v52, v54
    s_lshl_b32 s47, s43, 1
    v_add3_u32 v3, v52, v55, s47
    s_lshl_b32 s47, s43, 2
    s_add_u32 m0, s54, 0
    v_add_u32 v4, s47, v2
    buffer_load_dwordx4 v2, s[8:11], s45 offen lds
    s_add_u32 m0, s54, 1024
    v_add_u32 v5, s47, v3
    buffer_load_dwordx4 v3, s[8:11], s45 offen lds
    s_add_u32 m0, s54, 2048
    v_add_u32 v6, s47, v4
    buffer_load_dwordx4 v4, s[8:11], s45 offen lds
    s_add_u32 m0, s54, 3072
    v_add_u32 v7, s47, v5
    buffer_load_dwordx4 v5, s[8:11], s45 offen lds
    s_add_u32 m0, s54, 4096
    v_add_u32 v8, s47, v6
    buffer_load_dwordx4 v6, s[8:11], s45 offen lds
    s_add_u32 m0, s54, 5120
    v_add_u32 v9, s47, v7
    buffer_load_dwordx4 v7, s[8:11], s45 offen lds
    s_add_u32 m0, s54, 6144
    s_nop 0
    buffer_load_dwordx4 v8, s[8:11], s45 offen lds
    s_add_u32 m0, s54, 7168
    s_nop 0
    buffer_load_dwordx4 v9, s[8:11], s45 offen lds
    s_mov_b32 s78, s44
    s_lshl_b32 s43, s43, 6
    s_mov_b32 s12, s76
    s_mov_b32 s13, s77
    s_mov_b32 s14, 0x10000000
    s_mov_b32 s15, 0x20000
    s_mov_b32 s16, s74
    s_mov_b32 s17, s75
    s_mov_b32 s18, 256
    s_mov_b32 s19, 0x20000
    s_add_u32 s44, s44, 1
    s_cmp_eq_u32 s44, 10
    s_cselect_b32 s44, 0, s44
    s_lshl_b32 s46, s44, 7
    s_mul_i32 s45, s44, s43
    s_cmp_eq_u32 s2, 0
    s_cselect_b32 s48, 0, 1073741824
    v_cmp_eq_u32 vcc, 0, v0
    v_mov_b32 v58, 1073741824
    s_nop 0
    v_cndmask_b32 v58, v58, 0, vcc
    s_or_b32 s100, s100, 1
    v_mov_b32 v59, s100
    buffer_store_dword v59, v58, s[16:19], s48 offen sc1
    s_mov_b64 exec, 0
    s_and_b32 s48, s38, 0
    s_mov_b32 s49, 1
Lwarm_loop:
    s_cmp_eq_u32 s42, 1
    s_cbranch_scc1 Lwarm_q
    s_cmp_eq_u32 s36, 0
    s_cbranch_scc1 CH_M0_0
    s_cmp_eq_u32 s36, 1
    s_cbranch_scc1 CH_M1_0
    s_cmp_eq_u32 s36, 2
    s_cbranch_scc1 CH_M2_0
Lwarm_M3:
    s_branch CH_M3_0
Lwarm_q:
    s_cmp_eq_u32 s36, 0
    s_cbranch_scc1 CH_Q0_0
    s_cmp_eq_u32 s36, 1
    s_cbranch_scc1 CH_Q1_0
    s_cmp_eq_u32 s36, 2
    s_cbranch_scc1 CH_Q2_0
Lwarm_Q3:
    s_branch CH_Q3_0
Lwarm_ret0:
    s_mov_b64 exec, -1
    s_add_u32 m0, s54, 49152
    s_lshl_b32 s49, s2, 3
    s_lshl_b32 s48, s36, 1
    s_add_u32 s49, s49, s48
    v_lshrrev_b32 v56, 5, v1
    v_add_u32 v57, s49, v56
    v_mul_u32_u24 v56, 1280, v57
    v_and_b32 v58, 31, v1
    v_lshl_add_u32 v56, v58, 3, v56
    v_lshrrev_b32 v52, 4, v1
    v_and_b32 v53, 15, v1
    s_and_b32 s48, s36, 1
    s_lshl_b32 s48, s48, 3
    buffer_load_dwordx4 v2, s[8:11], s45 offen lds
    s_add_u32 m0, s54, 50176
    v_lshl_or_b32 v54, v52, 1, s48
    v_xor_b32 v53, v53, v54
    v_mul_u32_u24 v52, 1280, v52
    v_lshl_add_u32 v52, v53, 4, v52
    s_lshr_b32 s63, s2, 3
    s_lshl_b32 s63, s63, 2
    s_and_b32 s48, s2, 7
    s_add_u32 s63, s63, s48
    s_add_u32 s63, s63, 112
    s_add_u32 s49, s2, 185
    s_cmp_lt_u32 s48, 4
    s_cselect_b32 s63, s63, s49
    s_cmp_eq_u32 s2, 7
    s_cselect_b32 s63, 184, s63
    buffer_load_dwordx4 v3, s[8:11], s45 offen lds
    s_add_u32 m0, s55, 81920
    s_sub_u32 s49, 255, s2
    s_cmp_eq_u32 s42, 1
    s_cselect_b32 s63, s63, s49
    s_add_u32 s3, s63, 544
    s_mul_i32 s52, s63, 52429
    s_lshr_b32 s52, s52, 18
    s_mul_i32 s52, s52, 5
    s_add_u32 s63, s63, s52
    s_add_u32 s52, s63, 5
    s_mul_i32 s96, s63, 52429
    s_lshr_b32 s96, s96, 18
    s_mul_i32 s97, s96, 5
    s_sub_u32 s97, s63, s97
    buffer_load_dwordx4 v10, s[4:7], s46 offen lds
    s_add_u32 m0, s54, 51200
    s_sub_u32 s48, s96, 20
    s_lshr_b32 s49, s48, 3
    s_cmp_eq_u32 s49, 6
    s_cselect_b32 s50, 12, 16
    s_lshr_b32 s22, s36, 1
    s_mul_i32 s50, s50, s22
    s_and_b32 s22, s36, 1
    s_add_u32 s50, s50, s22
    s_lshl_b32 s49, s49, 5
    s_add_u32 s50, s50, s49
    s_and_b32 s48, s48, 7
    s_lshl_b32 s48, s48, 1
    s_add_u32 s50, s50, s48
    buffer_load_dwordx4 v4, s[8:11], s45 offen lds
    s_add_u32 m0, s54, 52224
    s_lshl_b32 s48, s96, 2
    s_add_u32 s48, s48, s36
    s_cmp_lt_u32 s96, 20
    s_cselect_b32 s50, s48, s50
    s_cselect_b32 s20, s60, s68
    s_cselect_b32 s21, s61, s69
    s_mov_b32 s22, 2211840
    s_cselect_b32 s22, 819200, s22
    s_cmp_lt_u32 s63, 370
    s_cselect_b32 s22, s22, 0
    s_mov_b32 s23, 0x20000
    s_mul_i32 s50, s50, 10240
    s_lshl_b32 s48, s97, 8
    s_add_u32 s50, s50, s48
    v_add_u32 v54, s50, v52
    s_mul_i32 s98, s52, 52429
    s_lshr_b32 s98, s98, 18
    s_mul_i32 s99, s98, 5
    s_sub_u32 s99, s52, s99
    buffer_load_dwordx4 v5, s[8:11], s45 offen lds
    s_add_u32 m0, s55, 82944
    s_sub_u32 s48, s98, 20
    s_lshr_b32 s49, s48, 3
    s_cmp_eq_u32 s49, 6
    s_cselect_b32 s50, 12, 16
    s_lshr_b32 s30, s36, 1
    s_mul_i32 s50, s50, s30
    s_and_b32 s30, s36, 1
    s_add_u32 s50, s50, s30
    s_lshl_b32 s49, s49, 5
    s_add_u32 s50, s50, s49
    s_and_b32 s48, s48, 7
    s_lshl_b32 s48, s48, 1
    s_add_u32 s50, s50, s48
    buffer_load_dwordx4 v11, s[4:7], s46 offen lds
    s_add_u32 m0, s54, 53248
    s_lshl_b32 s48, s98, 2
    s_add_u32 s48, s48, s36
    s_cmp_lt_u32 s98, 20
    s_cselect_b32 s50, s48, s50
    s_cselect_b32 s28, s60, s68
    s_cselect_b32 s29, s61, s69
    s_mov_b32 s30, 2211840
    s_cselect_b32 s30, 819200, s30
    s_cmp_lt_u32 s52, 370
    s_cselect_b32 s30, s30, 0
    s_mov_b32 s31, 0x20000
    s_mul_i32 s50, s50, 10240
    s_lshl_b32 s48, s99, 8
    s_add_u32 s50, s50, s48
    v_add_u32 v55, s50, v52
    v_bfe_u32 v52, v1, 4, 1
    v_lshrrev_b32 v53, 5, v1
    v_bfe_u32 v58, v1, 2, 2
    v_and_b32 v59, 1, v1
    buffer_load_dwordx4 v6, s[8:11], s45 offen lds
    s_add_u32 m0, s54, 54272
    v_bfe_u32 v70, v1, 1, 1
    v_lshl_add_u32 v53, v53, 3, v58
    v_lshlrev_b32 v53, 9, v53
    v_lshl_add_u32 v53, v59, 8, v53
    v_lshl_add_u32 v53, v70, 3, v53
    v_lshlrev_b32 v58, 2, v58
    v_lshl_or_b32 v58, v59, 1, v58
    v_xor_b32 v58, v58, v52
    v_lshl_add_u32 v14, v58, 4, v53
    v_xor_b32 v15, 32, v14
    v_xor_b32 v16, 64, v14
    v_xor_b32 v17, 96, v14
    buffer_load_dwordx4 v7, s[8:11], s45 offen lds
    s_add_u32 m0, s55, 83968
    v_xor_b32 v18, 128, v14
    v_xor_b32 v19, 160, v14
    v_xor_b32 v20, 192, v14
    v_xor_b32 v21, 224, v14
    v_add_u32 v22, 49152, v14
    v_add_u32 v23, 49152, v15
    v_add_u32 v24, 49152, v16
    v_add_u32 v25, 49152, v17
    v_add_u32 v26, 49152, v18
    v_add_u32 v27, 49152, v19
    v_add_u32 v28, 49152, v20
    v_add_u32 v29, 49152, v21
    buffer_load_dwordx4 v12, s[4:7], s46 offen lds
    s_add_u32 m0, s54, 55296
    v_add_u32 v30, 98304, v14
    v_add_u32 v31, 98304, v15
    v_add_u32 v32, 98304, v16
    v_add_u32 v33, 98304, v17
    v_add_u32 v34, 98304, v18
    v_add_u32 v35, 98304, v19
    v_add_u32 v36, 98304, v20
    v_add_u32 v37, 98304, v21
    s_lshl_b32 s48, s36, 6
    v_xor_b32 v50, s48, v14
    v_xor_b32 v51, 32, v50
    v_and_b32 v52, 31, v1
    buffer_load_dwordx4 v8, s[8:11], s45 offen lds
    s_add_u32 m0, s54, 56320
    v_lshrrev_b32 v53, 5, v1
    v_bfe_u32 v58, v1, 1, 3
    v_xor_b32 v53, v53, v58
    v_lshlrev_b32 v53, 4, v53
    v_lshl_add_u32 v53, v52, 7, v53
    s_add_u32 s48, s55, 32768
    v_add_u32 v38, s48, v53
    v_xor_b32 v39, 32, v38
    v_xor_b32 v40, 64, v38
    v_xor_b32 v41, 96, v38
    v_add_u32 v42, 49152, v38
    v_add_u32 v43, 49152, v39
    buffer_load_dwordx4 v9, s[8:11], s45 offen lds
    s_add_u32 m0, s55, 84992
    v_add_u32 v44, 49152, v40
    v_add_u32 v45, 49152, v41
    v_add_u32 v46, 98304, v38
    v_add_u32 v47, 98304, v39
    v_add_u32 v48, 98304, v40
    v_add_u32 v49, 98304, v41
    v_mov_b32 v120, 0x3f803f80
    v_mov_b32 v121, 0x3f803f80
    v_mov_b32 v122, 0x3f803f80
    v_mov_b32 v123, 0x3f803f80
    buffer_load_dwordx4 v13, s[4:7], s46 offen lds
    s_add_u32 s44, s44, 1
    s_cmp_eq_u32 s44, 10
    s_cselect_b32 s44, 0, s44
    s_lshl_b32 s46, s44, 7
    s_mul_i32 s45, s44, s43
    s_waitcnt vmcnt(13)
    s_barrier
    ds_read_b128 a[64:67], v38
    ds_read_b64_tr_b16 a[0:1], v14 offset:0
    ds_read_b64_tr_b16 a[2:3], v14 offset:2048
    ds_read_b64_tr_b16 a[4:5], v15 offset:0
    ds_read_b64_tr_b16 a[6:7], v15 offset:2048
    ds_read_b64_tr_b16 a[8:9], v16 offset:0
    ds_read_b64_tr_b16 a[10:11], v16 offset:2048
    ds_read_b64_tr_b16 a[12:13], v17 offset:0
    ds_read_b64_tr_b16 a[14:15], v17 offset:2048
    ds_read_b64_tr_b16 a[16:17], v18 offset:0
    ds_read_b64_tr_b16 a[18:19], v18 offset:2048
    ds_read_b64_tr_b16 a[20:21], v19 offset:0
    ds_read_b64_tr_b16 a[22:23], v19 offset:2048
    ds_read_b64_tr_b16 a[24:25], v20 offset:0
    ds_read_b64_tr_b16 a[26:27], v20 offset:2048
    ds_read_b64_tr_b16 a[28:29], v21 offset:0
    ds_read_b64_tr_b16 a[30:31], v21 offset:2048
    ds_read_b64_tr_b16 a[104:105], v50 offset:0
    ds_read_b64_tr_b16 a[106:107], v50 offset:2048
    ds_read_b64_tr_b16 a[108:109], v51 offset:0
    ds_read_b64_tr_b16 a[110:111], v51 offset:2048
    s_waitcnt lgkmcnt(15)
    v_mfma_f32_32x32x16_bf16 v[128:143], a[0:3], a[64:67], 0
    s_add_u32 m0, s54, 98304
    ds_read_b128 a[68:71], v39
    ds_read_b64_tr_b16 a[32:33], v14 offset:8192
    ds_read_b64_tr_b16 a[34:35], v14 offset:10240
    buffer_load_dwordx4 v2, s[8:11], s45 offen lds
    buffer_load_dwordx2 v[60:61], v56, s[4:7], 0 offen offset:0
    v_mfma_f32_32x32x16_bf16 v[144:159], a[4:7], a[64:67], 0
    ds_read_b64_tr_b16 a[36:37], v15 offset:8192
    ds_read_b64_tr_b16 a[38:39], v15 offset:10240
    ds_read_b64_tr_b16 a[40:41], v16 offset:8192
    buffer_load_dwordx2 v[62:63], v56, s[4:7], 0 offen offset:256
    s_waitcnt lgkmcnt(15)
    v_mfma_f32_32x32x16_bf16 v[160:175], a[8:11], a[64:67], 0
    ds_read_b64_tr_b16 a[42:43], v16 offset:10240
    ds_read_b64_tr_b16 a[44:45], v17 offset:8192
    ds_read_b64_tr_b16 a[46:47], v17 offset:10240
    buffer_load_dwordx2 v[64:65], v56, s[4:7], 0 offen offset:512
    v_mfma_f32_32x32x16_bf16 v[176:191], a[12:15], a[64:67], 0
    s_add_u32 m0, s54, 99328
    ds_read_b64_tr_b16 a[48:49], v18 offset:8192
    ds_read_b64_tr_b16 a[50:51], v18 offset:10240
    buffer_load_dwordx4 v3, s[8:11], s45 offen lds
    s_waitcnt lgkmcnt(15)
    v_mfma_f32_32x32x16_bf16 v[192:207], a[16:19], a[64:67], 0
    ds_read_b64_tr_b16 a[52:53], v19 offset:8192
    ds_read_b64_tr_b16 a[54:55], v19 offset:10240
    buffer_load_dwordx2 v[66:67], v56, s[4:7], 0 offen offset:768
    v_mfma_f32_32x32x16_bf16 v[208:223], a[20:23], a[64:67], 0
    s_add_u32 m0, s55, 131072
    ds_read_b64_tr_b16 a[56:57], v20 offset:8192
    ds_read_b64_tr_b16 a[58:59], v20 offset:10240
    buffer_load_dwordx4 v10, s[4:7], s46 offen lds
    buffer_load_dwordx2 v[68:69], v56, s[4:7], 0 offen offset:1024
    v_mfma_f32_32x32x16_bf16 v[224:239], a[24:27], a[64:67], 0
    ds_read_b64_tr_b16 a[60:61], v21 offset:8192
    ds_read_b64_tr_b16 a[62:63], v21 offset:10240
    s_lshl_b32 s48, s36, 11
    s_add_u32 m0, s48, 147456
    s_mov_b32 s49, 5120
    buffer_load_dwordx4 v54, s[20:23], 0 offen lds
    v_mfma_f32_32x32x16_bf16 v[240:255], a[28:31], a[64:67], 0
    ds_read_b64_tr_b16 a[112:113], v50 offset:8192
    ds_read_b64_tr_b16 a[114:115], v50 offset:10240
    s_waitcnt lgkmcnt(15)
    v_mfma_f32_32x32x16_bf16 a[72:87], v[120:123], a[104:107], 0
    s_add_u32 m0, s54, 100352
    ds_read_b64_tr_b16 a[116:117], v51 offset:8192
    buffer_load_dwordx4 v4, s[8:11], s45 offen lds
    s_lshl_b32 s48, s36, 11
    s_add_u32 m0, s48, 148480
    s_mov_b32 s49, 5120
    buffer_load_dwordx4 v54, s[20:23], s49 offen lds
    v_mfma_f32_32x32x16_bf16 a[88:103], v[120:123], a[108:111], 0
    ds_read_b64_tr_b16 a[118:119], v51 offset:10240
    s_waitcnt lgkmcnt(15)
    v_mfma_f32_32x32x16_bf16 v[128:143], a[32:35], a[68:71], v[128:143]
    s_add_u32 m0, s54, 101376
    ds_read_b128 a[64:67], v40
    ds_read_b64_tr_b16 a[0:1], v14 offset:16384
    ds_read_b64_tr_b16 a[2:3], v14 offset:18432
    buffer_load_dwordx4 v5, s[8:11], s45 offen lds
    s_lshl_b32 s48, s36, 11
    s_add_u32 m0, s48, 155648
    s_mov_b32 s49, 5120
    buffer_load_dwordx4 v55, s[28:31], 0 offen lds
    v_mfma_f32_32x32x16_bf16 v[144:159], a[36:39], a[68:71], v[144:159]
    ds_read_b64_tr_b16 a[4:5], v15 offset:16384
    ds_read_b64_tr_b16 a[6:7], v15 offset:18432
    ds_read_b64_tr_b16 a[8:9], v16 offset:16384
    s_waitcnt lgkmcnt(15)
    v_mfma_f32_32x32x16_bf16 v[160:175], a[40:43], a[68:71], v[160:175]
    ds_read_b64_tr_b16 a[10:11], v16 offset:18432
    ds_read_b64_tr_b16 a[12:13], v17 offset:16384
    ds_read_b64_tr_b16 a[14:15], v17 offset:18432
    s_lshl_b32 s48, s36, 11
    s_add_u32 m0, s48, 156672
    s_mov_b32 s49, 5120
    buffer_load_dwordx4 v55, s[28:31], s49 offen lds
    v_mfma_f32_32x32x16_bf16 v[176:191], a[44:47], a[68:71], v[176:191]
    s_add_u32 m0, s55, 132096
    ds_read_b64_tr_b16 a[16:17], v18 offset:16384
    ds_read_b64_tr_b16 a[18:19], v18 offset:18432
    buffer_load_dwordx4 v11, s[4:7], s46 offen lds
    s_waitcnt lgkmcnt(15)
    v_mfma_f32_32x32x16_bf16 v[192:207], a[48:51], a[68:71], v[192:207]
    ds_read_b64_tr_b16 a[20:21], v19 offset:16384
    ds_read_b64_tr_b16 a[22:23], v19 offset:18432
    v_mfma_f32_32x32x16_bf16 v[208:223], a[52:55], a[68:71], v[208:223]
    s_add_u32 m0, s54, 102400
    ds_read_b64_tr_b16 a[24:25], v20 offset:16384
    ds_read_b64_tr_b16 a[26:27], v20 offset:18432
    buffer_load_dwordx4 v6, s[8:11], s45 offen lds
    v_mfma_f32_32x32x16_bf16 v[224:239], a[56:59], a[68:71], v[224:239]
    ds_read_b64_tr_b16 a[28:29], v21 offset:16384
    ds_read_b64_tr_b16 a[30:31], v21 offset:18432
    v_mfma_f32_32x32x16_bf16 v[240:255], a[60:63], a[68:71], v[240:255]
    ds_read_b64_tr_b16 a[104:105], v50 offset:16384
    ds_read_b64_tr_b16 a[106:107], v50 offset:18432
    s_waitcnt lgkmcnt(15)
    v_mfma_f32_32x32x16_bf16 a[72:87], v[120:123], a[112:115], a[72:87]
    s_add_u32 m0, s54, 103424
    ds_read_b64_tr_b16 a[108:109], v51 offset:16384
    buffer_load_dwordx4 v7, s[8:11], s45 offen lds
    v_mfma_f32_32x32x16_bf16 a[88:103], v[120:123], a[116:119], a[88:103]
    ds_read_b64_tr_b16 a[110:111], v51 offset:18432
    s_waitcnt lgkmcnt(15)
    v_mfma_f32_32x32x16_bf16 v[128:143], a[0:3], a[64:67], v[128:143]
    s_add_u32 m0, s55, 133120
    ds_read_b128 a[68:71], v41
    ds_read_b64_tr_b16 a[32:33], v14 offset:24576
    ds_read_b64_tr_b16 a[34:35], v14 offset:26624
    buffer_load_dwordx4 v12, s[4:7], s46 offen lds
    v_mfma_f32_32x32x16_bf16 v[144:159], a[4:7], a[64:67], v[144:159]
    ds_read_b64_tr_b16 a[36:37], v15 offset:24576
    ds_read_b64_tr_b16 a[38:39], v15 offset:26624
    ds_read_b64_tr_b16 a[40:41], v16 offset:24576
    s_waitcnt lgkmcnt(15)
    v_mfma_f32_32x32x16_bf16 v[160:175], a[8:11], a[64:67], v[160:175]
    ds_read_b64_tr_b16 a[42:43], v16 offset:26624
    ds_read_b64_tr_b16 a[44:45], v17 offset:24576
    ds_read_b64_tr_b16 a[46:47], v17 offset:26624
    v_mfma_f32_32x32x16_bf16 v[176:191], a[12:15], a[64:67], v[176:191]
    s_add_u32 m0, s54, 104448
    ds_read_b64_tr_b16 a[48:49], v18 offset:24576
    ds_read_b64_tr_b16 a[50:51], v18 offset:26624
    buffer_load_dwordx4 v8, s[8:11], s45 offen lds
    s_waitcnt lgkmcnt(15)
    v_mfma_f32_32x32x16_bf16 v[192:207], a[16:19], a[64:67], v[192:207]
    ds_read_b64_tr_b16 a[52:53], v19 offset:24576
    ds_read_b64_tr_b16 a[54:55], v19 offset:26624
    v_mfma_f32_32x32x16_bf16 v[208:223], a[20:23], a[64:67], v[208:223]
    s_add_u32 m0, s54, 105472
    ds_read_b64_tr_b16 a[56:57], v20 offset:24576
    ds_read_b64_tr_b16 a[58:59], v20 offset:26624
    buffer_load_dwordx4 v9, s[8:11], s45 offen lds
    v_mfma_f32_32x32x16_bf16 v[224:239], a[24:27], a[64:67], v[224:239]
    ds_read_b64_tr_b16 a[60:61], v21 offset:24576
    ds_read_b64_tr_b16 a[62:63], v21 offset:26624
    v_mfma_f32_32x32x16_bf16 v[240:255], a[28:31], a[64:67], v[240:255]
    ds_read_b64_tr_b16 a[112:113], v50 offset:24576
    ds_read_b64_tr_b16 a[114:115], v50 offset:26624
    s_waitcnt lgkmcnt(15)
    v_mfma_f32_32x32x16_bf16 a[72:87], v[120:123], a[104:107], a[72:87]
    s_add_u32 m0, s55, 134144
    ds_read_b64_tr_b16 a[116:117], v51 offset:24576
    buffer_load_dwordx4 v13, s[4:7], s46 offen lds
    s_add_u32 s44, s44, 1
    s_cmp_eq_u32 s44, 10
    s_cselect_b32 s44, 0, s44
    s_lshl_b32 s46, s44, 7
    s_mul_i32 s45, s44, s43
    v_mfma_f32_32x32x16_bf16 a[88:103], v[120:123], a[108:111], a[88:103]
    ds_read_b64_tr_b16 a[118:119], v51 offset:26624
    s_waitcnt lgkmcnt(0)
    s_waitcnt vmcnt(21)
    s_barrier
    v_mfma_f32_32x32x16_bf16 v[128:143], a[32:35], a[68:71], v[128:143]
    s_add_u32 m0, s54, 0
    ds_read_b128 a[64:67], v42
    ds_read_b64_tr_b16 a[0:1], v22 offset:0
    ds_read_b64_tr_b16 a[2:3], v22 offset:2048
    buffer_load_dwordx4 v2, s[8:11], s45 offen lds
    v_mfma_f32_32x32x16_bf16 v[144:159], a[36:39], a[68:71], v[144:159]
    ds_read_b64_tr_b16 a[4:5], v23 offset:0
    ds_read_b64_tr_b16 a[6:7], v23 offset:2048
    ds_read_b64_tr_b16 a[8:9], v24 offset:0
    v_mfma_f32_32x32x16_bf16 v[160:175], a[40:43], a[68:71], v[160:175]
    ds_read_b64_tr_b16 a[10:11], v24 offset:2048
    ds_read_b64_tr_b16 a[12:13], v25 offset:0
    ds_read_b64_tr_b16 a[14:15], v25 offset:2048
    s_waitcnt vmcnt(14)
    v_lshlrev_b32 v70, 16, v60
    v_and_b32 v71, 0xffff0000, v60
    v_lshlrev_b32 v72, 16, v61
    v_and_b32 v73, 0xffff0000, v61
    v_mfma_f32_32x32x16_bf16 v[176:191], a[44:47], a[68:71], v[176:191]
    s_add_u32 m0, s54, 1024
    ds_read_b64_tr_b16 a[16:17], v26 offset:0
    ds_read_b64_tr_b16 a[18:19], v26 offset:2048
    buffer_load_dwordx4 v3, s[8:11], s45 offen lds
    v_lshlrev_b32 v74, 16, v62
    v_and_b32 v75, 0xffff0000, v62
    v_lshlrev_b32 v76, 16, v63
    v_mfma_f32_32x32x16_bf16 v[192:207], a[48:51], a[68:71], v[192:207]
    ds_read_b64_tr_b16 a[20:21], v27 offset:0
    ds_read_b64_tr_b16 a[22:23], v27 offset:2048
    v_and_b32 v77, 0xffff0000, v63
    v_lshlrev_b32 v78, 16, v64
    v_and_b32 v79, 0xffff0000, v64
    v_lshlrev_b32 v80, 16, v65
    v_and_b32 v81, 0xffff0000, v65
    v_mfma_f32_32x32x16_bf16 v[208:223], a[52:55], a[68:71], v[208:223]
    s_add_u32 m0, s55, 32768
    ds_read_b64_tr_b16 a[24:25], v28 offset:0
    ds_read_b64_tr_b16 a[26:27], v28 offset:2048
    buffer_load_dwordx4 v10, s[4:7], s46 offen lds
    v_lshlrev_b32 v82, 16, v66
    v_and_b32 v83, 0xffff0000, v66
    v_lshlrev_b32 v84, 16, v67
    v_mfma_f32_32x32x16_bf16 v[224:239], a[56:59], a[68:71], v[224:239]
    ds_read_b64_tr_b16 a[28:29], v29 offset:0
    ds_read_b64_tr_b16 a[30:31], v29 offset:2048
    v_and_b32 v85, 0xffff0000, v67
    v_lshlrev_b32 v86, 16, v68
    v_and_b32 v87, 0xffff0000, v68
    v_lshlrev_b32 v88, 16, v69
    v_and_b32 v89, 0xffff0000, v69
    v_mfma_f32_32x32x16_bf16 v[240:255], a[60:63], a[68:71], v[240:255]
    v_add_f32 v60, v70, v71
    v_add_f32 v61, v72, v73
    v_add_f32 v60, v60, v74
    v_add_f32 v61, v61, v75
    v_add_f32 v60, v60, v76
    v_mfma_f32_32x32x16_bf16 a[72:87], v[120:123], a[112:115], a[72:87]
    s_add_u32 m0, s54, 2048
    s_nop 0
    buffer_load_dwordx4 v4, s[8:11], s45 offen lds
    v_add_f32 v61, v61, v77
    v_add_f32 v60, v60, v78
    v_add_f32 v61, v61, v79
    v_mfma_f32_32x32x16_bf16 a[88:103], v[120:123], a[116:119], a[88:103]
    v_add_f32 v60, v60, v80
    v_add_f32 v61, v61, v81
    v_add_f32 v60, v60, v82
    v_add_f32 v61, v61, v83
    v_add_f32 v60, v60, v84
    s_waitcnt lgkmcnt(12)
    v_mfma_f32_32x32x16_bf16 v[128:143], a[0:3], a[64:67], v[128:143]
    s_add_u32 m0, s54, 3072
    ds_read_b128 a[68:71], v43
    ds_read_b64_tr_b16 a[32:33], v22 offset:8192
    ds_read_b64_tr_b16 a[34:35], v22 offset:10240
    buffer_load_dwordx4 v5, s[8:11], s45 offen lds
    v_add_f32 v61, v61, v85
    v_add_f32 v60, v60, v86
    v_add_f32 v61, v61, v87
    v_mfma_f32_32x32x16_bf16 v[144:159], a[4:7], a[64:67], v[144:159]
    ds_read_b64_tr_b16 a[36:37], v23 offset:8192
    ds_read_b64_tr_b16 a[38:39], v23 offset:10240
    ds_read_b64_tr_b16 a[40:41], v24 offset:8192
    v_add_f32 v60, v60, v88
    v_add_f32 v61, v61, v89
    v_add_f32 v60, v60, v61
    s_nop 1
    v_add_f32_dpp v60, v60, v60 row_ror:8 row_mask:0xf bank_mask:0xf
    s_nop 1
    v_add_f32_dpp v60, v60, v60 row_ror:4 row_mask:0xf bank_mask:0xf
    s_waitcnt lgkmcnt(14)
    v_mfma_f32_32x32x16_bf16 v[160:175], a[8:11], a[64:67], v[160:175]
    ds_read_b64_tr_b16 a[42:43], v24 offset:10240
    ds_read_b64_tr_b16 a[44:45], v25 offset:8192
    v_add_f32_dpp v60, v60, v60 row_ror:2 row_mask:0xf bank_mask:0xf
    s_nop 1
    v_add_f32_dpp v60, v60, v60 row_ror:1 row_mask:0xf bank_mask:0xf
    v_mov_b32 v62, v60
    s_nop 1
    v_permlane16_swap_b32 v60, v62
    v_mfma_f32_32x32x16_bf16 v[176:191], a[12:15], a[64:67], v[176:191]
    s_add_u32 m0, s55, 33792
    ds_read_b64_tr_b16 a[46:47], v25 offset:10240
    ds_read_b64_tr_b16 a[48:49], v26 offset:8192
    buffer_load_dwordx4 v11, s[4:7], s46 offen lds
    v_add_f32 v60, v60, v62
    v_mul_f32 v60, 0x3acccccd, v60
    s_waitcnt lgkmcnt(14)
    v_mfma_f32_32x32x16_bf16 v[192:207], a[16:19], a[64:67], v[192:207]
    ds_read_b64_tr_b16 a[50:51], v26 offset:10240
    ds_read_b64_tr_b16 a[52:53], v27 offset:8192
    v_sub_f32 v70, v70, v60
    v_sub_f32 v71, v71, v60
    v_sub_f32 v72, v72, v60
    v_sub_f32 v73, v73, v60
    v_sub_f32 v74, v74, v60
    v_mfma_f32_32x32x16_bf16 v[208:223], a[20:23], a[64:67], v[208:223]
    s_add_u32 m0, s54, 4096
    ds_read_b64_tr_b16 a[54:55], v27 offset:10240
    ds_read_b64_tr_b16 a[56:57], v28 offset:8192
    buffer_load_dwordx4 v6, s[8:11], s45 offen lds
    v_sub_f32 v75, v75, v60
    v_sub_f32 v76, v76, v60
    v_sub_f32 v77, v77, v60
    s_waitcnt lgkmcnt(14)
    v_mfma_f32_32x32x16_bf16 v[224:239], a[24:27], a[64:67], v[224:239]
    ds_read_b64_tr_b16 a[58:59], v28 offset:10240
    ds_read_b64_tr_b16 a[60:61], v29 offset:8192
    v_sub_f32 v78, v78, v60
    v_sub_f32 v79, v79, v60
    v_sub_f32 v80, v80, v60
    v_sub_f32 v81, v81, v60
    v_sub_f32 v82, v82, v60
    v_mfma_f32_32x32x16_bf16 v[240:255], a[28:31], a[64:67], v[240:255]
    ds_read_b64_tr_b16 a[62:63], v29 offset:10240
    v_sub_f32 v83, v83, v60
    v_sub_f32 v84, v84, v60
    v_sub_f32 v85, v85, v60
    v_sub_f32 v86, v86, v60
    v_sub_f32 v87, v87, v60
    s_waitcnt lgkmcnt(12)
    v_mfma_f32_32x32x16_bf16 v[128:143], a[32:35], a[68:71], v[128:143]
    s_add_u32 m0, s54, 5120
    ds_read_b128 a[64:67], v44
    ds_read_b64_tr_b16 a[0:1], v22 offset:16384
    ds_read_b64_tr_b16 a[2:3], v22 offset:18432
    buffer_load_dwordx4 v7, s[8:11], s45 offen lds
    v_sub_f32 v88, v88, v60
    v_sub_f32 v89, v89, v60
    v_mul_f32 v61, v70, v70
    v_mfma_f32_32x32x16_bf16 v[144:159], a[36:39], a[68:71], v[144:159]
    ds_read_b64_tr_b16 a[4:5], v23 offset:16384
    ds_read_b64_tr_b16 a[6:7], v23 offset:18432
    ds_read_b64_tr_b16 a[8:9], v24 offset:16384
    v_mul_f32 v62, v71, v71
    v_fmac_f32 v61, v72, v72
    v_fmac_f32 v62, v73, v73
    v_fmac_f32 v61, v74, v74
    v_fmac_f32 v62, v75, v75
    s_waitcnt lgkmcnt(14)
    v_mfma_f32_32x32x16_bf16 v[160:175], a[40:43], a[68:71], v[160:175]
    s_add_u32 m0, s55, 34816
    ds_read_b64_tr_b16 a[10:11], v24 offset:18432
    ds_read_b64_tr_b16 a[12:13], v25 offset:16384
    buffer_load_dwordx4 v12, s[4:7], s46 offen lds
    v_fmac_f32 v61, v76, v76
    v_fmac_f32 v62, v77, v77
    v_fmac_f32 v61, v78, v78
    v_mfma_f32_32x32x16_bf16 v[176:191], a[44:47], a[68:71], v[176:191]
    ds_read_b64_tr_b16 a[14:15], v25 offset:18432
    ds_read_b64_tr_b16 a[16:17], v26 offset:16384
    v_fmac_f32 v62, v79, v79
    v_fmac_f32 v61, v80, v80
    v_fmac_f32 v62, v81, v81
    v_fmac_f32 v61, v82, v82
    v_fmac_f32 v62, v83, v83
    s_waitcnt lgkmcnt(14)
    v_mfma_f32_32x32x16_bf16 v[192:207], a[48:51], a[68:71], v[192:207]
    ds_read_b64_tr_b16 a[18:19], v26 offset:18432
    ds_read_b64_tr_b16 a[20:21], v27 offset:16384
    v_fmac_f32 v61, v84, v84
    v_fmac_f32 v62, v85, v85
    v_fmac_f32 v61, v86, v86
    v_fmac_f32 v62, v87, v87
    v_fmac_f32 v61, v88, v88
    v_mfma_f32_32x32x16_bf16 v[208:223], a[52:55], a[68:71], v[208:223]
    s_add_u32 m0, s54, 6144
    ds_read_b64_tr_b16 a[22:23], v27 offset:18432
    ds_read_b64_tr_b16 a[24:25], v28 offset:16384
    buffer_load_dwordx4 v8, s[8:11], s45 offen lds
    v_fmac_f32 v62, v89, v89
    v_add_f32 v61, v61, v62
    s_nop 1
    v_add_f32_dpp v61, v61, v61 row_ror:8 row_mask:0xf bank_mask:0xf
    s_waitcnt lgkmcnt(14)
    v_mfma_f32_32x32x16_bf16 v[224:239], a[56:59], a[68:71], v[224:239]
    ds_read_b64_tr_b16 a[26:27], v28 offset:18432
    ds_read_b64_tr_b16 a[28:29], v29 offset:16384
    v_add_f32_dpp v61, v61, v61 row_ror:4 row_mask:0xf bank_mask:0xf
    s_nop 1
    v_add_f32_dpp v61, v61, v61 row_ror:2 row_mask:0xf bank_mask:0xf
    s_nop 1
    v_add_f32_dpp v61, v61, v61 row_ror:1 row_mask:0xf bank_mask:0xf
    v_mov_b32 v62, v61
    v_mfma_f32_32x32x16_bf16 v[240:255], a[60:63], a[68:71], v[240:255]
    s_add_u32 m0, s54, 7168
    ds_read_b64_tr_b16 a[30:31], v29 offset:18432
    buffer_load_dwordx4 v9, s[8:11], s45 offen lds
    v_permlane16_swap_b32 v61, v62
    v_add_f32 v61, v61, v62
    s_waitcnt lgkmcnt(12)
    v_mfma_f32_32x32x16_bf16 v[128:143], a[0:3], a[64:67], v[128:143]
    ds_read_b128 a[68:71], v45
    ds_read_b64_tr_b16 a[32:33], v22 offset:24576
    ds_read_b64_tr_b16 a[34:35], v22 offset:26624
    v_mul_f32 v61, 0x3acccccd, v61
    v_and_b32 v58, 31, v1
    v_cmp_eq_u32 vcc, 0, v58
    v_lshlrev_b32 v57, 3, v57
    v_mov_b32 v58, 1073741824
    v_mfma_f32_32x32x16_bf16 v[144:159], a[4:7], a[64:67], v[144:159]
    ds_read_b64_tr_b16 a[36:37], v23 offset:24576
    ds_read_b64_tr_b16 a[38:39], v23 offset:26624
    ds_read_b64_tr_b16 a[40:41], v24 offset:24576
    v_cndmask_b32 v57, v58, v57, vcc
    s_mov_b32 s48, 13631488
    buffer_store_dwordx2 v[60:61], v57, s[12:15], s48 offen sc1
    v_lshrrev_b32 v52, 4, v1
    v_bfe_u32 v53, v1, 2, 2
    s_waitcnt lgkmcnt(14)
    v_mfma_f32_32x32x16_bf16 v[160:175], a[8:11], a[64:67], v[160:175]
    s_add_u32 m0, s55, 35840
    ds_read_b64_tr_b16 a[42:43], v24 offset:26624
    ds_read_b64_tr_b16 a[44:45], v25 offset:24576
    buffer_load_dwordx4 v13, s[4:7], s46 offen lds
    s_add_u32 s44, s44, 1
    s_cmp_eq_u32 s44, 10
    s_cselect_b32 s44, 0, s44
    s_lshl_b32 s46, s44, 7
    s_mul_i32 s45, s44, s43
    v_bfe_u32 v54, v1, 1, 1
    v_and_b32 v55, 1, v1
    v_and_b32 v56, 1, v52
    v_mfma_f32_32x32x16_bf16 v[176:191], a[12:15], a[64:67], v[176:191]
    ds_read_b64_tr_b16 a[46:47], v25 offset:26624
    ds_read_b64_tr_b16 a[48:49], v26 offset:24576
    v_lshlrev_b32 v56, 3, v56
    v_lshl_or_b32 v56, v53, 1, v56
    v_xor_b32 v54, v54, v56
    s_lshl_b32 s48, s36, 2
    v_xor_b32 v54, s48, v54
    s_waitcnt lgkmcnt(14)
    v_mfma_f32_32x32x16_bf16 v[192:207], a[16:19], a[64:67], v[192:207]
    ds_read_b64_tr_b16 a[50:51], v26 offset:26624
    ds_read_b64_tr_b16 a[52:53], v27 offset:24576
    v_lshlrev_b32 v52, 11, v52
    v_lshl_add_u32 v52, v53, 8, v52
    v_lshl_add_u32 v52, v54, 4, v52
    v_lshl_add_u32 v52, v55, 3, v52
    v_add_u32 v52, 147456, v52
    v_mfma_f32_32x32x16_bf16 v[208:223], a[20:23], a[64:67], v[208:223]
    ds_read_b64_tr_b16 a[54:55], v27 offset:26624
    ds_read_b64_tr_b16 a[56:57], v28 offset:24576
    v_xor_b32 v53, 32, v52
    v_lshlrev_b32 v54, 4, v1
    s_waitcnt lgkmcnt(14)
    v_mfma_f32_32x32x16_bf16 v[224:239], a[24:27], a[64:67], v[224:239]
    ds_read_b64_tr_b16 a[58:59], v28 offset:26624
    ds_read_b64_tr_b16 a[60:61], v29 offset:24576
    v_mfma_f32_32x32x16_bf16 v[240:255], a[28:31], a[64:67], v[240:255]
    ds_read_b64_tr_b16 a[62:63], v29 offset:26624
    s_waitcnt lgkmcnt(0)
    s_waitcnt vmcnt(13)
    s_barrier
    v_mfma_f32_32x32x16_bf16 v[128:143], a[32:35], a[68:71], v[128:143]
    s_add_u32 m0, s54, 49152
    ds_read_b128 a[64:67], v46
    ds_read_b64_tr_b16 a[0:1], v30 offset:0
    ds_read_b64_tr_b16 a[2:3], v30 offset:2048
    buffer_load_dwordx4 v2, s[8:11], s45 offen lds
    ds_read_b64_tr_b16 v[70:71], v52 offset:0
    ds_read_b64_tr_b16 v[72:73], v52 offset:1024
    v_mfma_f32_32x32x16_bf16 v[144:159], a[36:39], a[68:71], v[144:159]
    ds_read_b64_tr_b16 a[4:5], v31 offset:0
    ds_read_b64_tr_b16 a[6:7], v31 offset:2048
    ds_read_b64_tr_b16 a[8:9], v32 offset:0
    ds_read_b64_tr_b16 v[74:75], v53 offset:0
    ds_read_b64_tr_b16 v[76:77], v53 offset:1024
    ds_read_b64_tr_b16 v[78:79], v52 offset:8192
    ds_read_b64_tr_b16 v[80:81], v52 offset:9216
    v_mfma_f32_32x32x16_bf16 v[160:175], a[40:43], a[68:71], v[160:175]
    ds_read_b64_tr_b16 a[10:11], v32 offset:2048
    ds_read_b64_tr_b16 a[12:13], v33 offset:0
    ds_read_b64_tr_b16 v[82:83], v53 offset:8192
    ds_read_b64_tr_b16 v[84:85], v53 offset:9216
    s_lshl_b32 s48, s97, 3
    s_lshl_b32 s49, s36, 1
    s_add_u32 s48, s48, s49
    s_add_u32 s48, s48, 0
    v_mfma_f32_32x32x16_bf16 v[176:191], a[44:47], a[68:71], v[176:191]
    s_add_u32 m0, s54, 50176
    ds_read_b64_tr_b16 a[14:15], v33 offset:2048
    ds_read_b64_tr_b16 a[16:17], v34 offset:0
    buffer_load_dwordx4 v3, s[8:11], s45 offen lds
    s_mul_i32 s49, s48, 205
    s_lshr_b32 s49, s49, 10
    s_mul_i32 s49, s49, 365
    s_add_u32 s48, s48, s49
    v_mfma_f32_32x32x16_bf16 v[192:207], a[48:51], a[68:71], v[192:207]
    ds_read_b64_tr_b16 a[18:19], v34 offset:2048
    ds_read_b64_tr_b16 a[20:21], v35 offset:0
    s_mul_i32 s49, s96, 5
    s_add_u32 s48, s48, s49
    s_lshl_b32 s48, s48, 10
    s_add_u32 s48, s48, 10485760
    v_mfma_f32_32x32x16_bf16 v[208:223], a[52:55], a[68:71], v[208:223]
    s_add_u32 m0, s55, 81920
    ds_read_b64_tr_b16 a[22:23], v35 offset:2048
    ds_read_b64_tr_b16 a[24:25], v36 offset:0
    buffer_load_dwordx4 v10, s[4:7], s46 offen lds
    s_cmp_lt_u32 s96, 74
    s_cselect_b32 s48, s48, 1073741824
    s_waitcnt lgkmcnt(15)
    buffer_store_dwordx4 v[70:73], v54, s[12:15], s48 offen sc1
    v_mfma_f32_32x32x16_bf16 v[224:239], a[56:59], a[68:71], v[224:239]
    ds_read_b64_tr_b16 a[26:27], v36 offset:2048
    ds_read_b64_tr_b16 a[28:29], v37 offset:0
    s_lshl_b32 s48, s97, 3
    s_lshl_b32 s49, s36, 1
    s_add_u32 s48, s48, s49
    s_add_u32 s48, s48, 1
    v_mfma_f32_32x32x16_bf16 v[240:255], a[60:63], a[68:71], v[240:255]
    ds_read_b64_tr_b16 a[30:31], v37 offset:2048
    s_mul_i32 s49, s48, 205
    s_lshr_b32 s49, s49, 10
    s_mul_i32 s49, s49, 365
    s_add_u32 s48, s48, s49
    v_mfma_f32_32x32x16_bf16 v[128:143], a[0:3], a[64:67], v[128:143]
    s_add_u32 m0, s54, 51200
    ds_read_b128 a[68:71], v47
    ds_read_b64_tr_b16 a[32:33], v30 offset:8192
    ds_read_b64_tr_b16 a[34:35], v30 offset:10240
    buffer_load_dwordx4 v4, s[8:11], s45 offen lds
    s_mul_i32 s49, s96, 5
    s_add_u32 s48, s48, s49
    s_lshl_b32 s48, s48, 10
    s_add_u32 s48, s48, 10485760
    v_mfma_f32_32x32x16_bf16 v[144:159], a[4:7], a[64:67], v[144:159]
    ds_read_b64_tr_b16 a[36:37], v31 offset:8192
    ds_read_b64_tr_b16 a[38:39], v31 offset:10240
    ds_read_b64_tr_b16 a[40:41], v32 offset:8192
    s_cmp_lt_u32 s96, 74
    s_cselect_b32 s48, s48, 1073741824
    s_waitcnt lgkmcnt(15)
    buffer_store_dwordx4 v[74:77], v54, s[12:15], s48 offen sc1
    s_waitcnt lgkmcnt(14)
    v_mfma_f32_32x32x16_bf16 v[160:175], a[8:11], a[64:67], v[160:175]
    s_add_u32 m0, s54, 52224
    ds_read_b64_tr_b16 a[42:43], v32 offset:10240
    ds_read_b64_tr_b16 a[44:45], v33 offset:8192
    buffer_load_dwordx4 v5, s[8:11], s45 offen lds
    s_lshl_b32 s48, s99, 3
    s_lshl_b32 s49, s36, 1
    s_add_u32 s48, s48, s49
    s_add_u32 s48, s48, 0
    v_mfma_f32_32x32x16_bf16 v[176:191], a[12:15], a[64:67], v[176:191]
    ds_read_b64_tr_b16 a[46:47], v33 offset:10240
    ds_read_b64_tr_b16 a[48:49], v34 offset:8192
    s_mul_i32 s49, s48, 205
    s_lshr_b32 s49, s49, 10
    s_mul_i32 s49, s49, 365
    s_add_u32 s48, s48, s49
    s_waitcnt lgkmcnt(14)
    v_mfma_f32_32x32x16_bf16 v[192:207], a[16:19], a[64:67], v[192:207]
    ds_read_b64_tr_b16 a[50:51], v34 offset:10240
    ds_read_b64_tr_b16 a[52:53], v35 offset:8192
    s_mul_i32 s49, s98, 5
    s_add_u32 s48, s48, s49
    s_lshl_b32 s48, s48, 10
    s_add_u32 s48, s48, 10485760
    v_mfma_f32_32x32x16_bf16 v[208:223], a[20:23], a[64:67], v[208:223]
    s_add_u32 m0, s55, 82944
    ds_read_b64_tr_b16 a[54:55], v35 offset:10240
    ds_read_b64_tr_b16 a[56:57], v36 offset:8192
    buffer_load_dwordx4 v11, s[4:7], s46 offen lds
    s_cmp_lt_u32 s98, 74
    s_cselect_b32 s48, s48, 1073741824
    buffer_store_dwordx4 v[78:81], v54, s[12:15], s48 offen sc1
    s_waitcnt lgkmcnt(14)
    v_mfma_f32_32x32x16_bf16 v[224:239], a[24:27], a[64:67], v[224:239]
    ds_read_b64_tr_b16 a[58:59], v36 offset:10240
    ds_read_b64_tr_b16 a[60:61], v37 offset:8192
    s_lshl_b32 s48, s99, 3
    s_lshl_b32 s49, s36, 1
    s_add_u32 s48, s48, s49
    s_add_u32 s48, s48, 1
    v_mfma_f32_32x32x16_bf16 v[240:255], a[28:31], a[64:67], v[240:255]
    s_add_u32 m0, s54, 53248
    ds_read_b64_tr_b16 a[62:63], v37 offset:10240
    buffer_load_dwordx4 v6, s[8:11], s45 offen lds
    s_mul_i32 s49, s48, 205
    s_lshr_b32 s49, s49, 10
    s_mul_i32 s49, s49, 365
    s_add_u32 s48, s48, s49
    s_waitcnt lgkmcnt(12)
    v_mfma_f32_32x32x16_bf16 v[128:143], a[32:35], a[68:71], v[128:143]
    ds_read_b128 a[64:67], v48
    ds_read_b64_tr_b16 a[0:1], v30 offset:16384
    ds_read_b64_tr_b16 a[2:3], v30 offset:18432
    s_mul_i32 s49, s98, 5
    s_add_u32 s48, s48, s49
    s_lshl_b32 s48, s48, 10
    s_add_u32 s48, s48, 10485760
    v_mfma_f32_32x32x16_bf16 v[144:159], a[36:39], a[68:71], v[144:159]
    ds_read_b64_tr_b16 a[4:5], v31 offset:16384
    ds_read_b64_tr_b16 a[6:7], v31 offset:18432
    ds_read_b64_tr_b16 a[8:9], v32 offset:16384
    s_cmp_lt_u32 s98, 74
    s_cselect_b32 s48, s48, 1073741824
    buffer_store_dwordx4 v[82:85], v54, s[12:15], s48 offen sc1
    s_waitcnt lgkmcnt(14)
    v_mfma_f32_32x32x16_bf16 v[160:175], a[40:43], a[68:71], v[160:175]
    s_add_u32 m0, s54, 54272
    ds_read_b64_tr_b16 a[10:11], v32 offset:18432
    ds_read_b64_tr_b16 a[12:13], v33 offset:16384
    buffer_load_dwordx4 v7, s[8:11], s45 offen lds
    v_mfma_f32_32x32x16_bf16 v[176:191], a[44:47], a[68:71], v[176:191]
    ds_read_b64_tr_b16 a[14:15], v33 offset:18432
    ds_read_b64_tr_b16 a[16:17], v34 offset:16384
    v_accvgpr_read_b32 v90, a72
    v_accvgpr_read_b32 v91, a88
    v_cmp_gt_u32 vcc, 32, v1
    v_bfe_u32 v92, v1, 4, 2
    s_waitcnt lgkmcnt(14)
    v_mfma_f32_32x32x16_bf16 v[192:207], a[48:51], a[68:71], v[192:207]
    s_add_u32 m0, s55, 83968
    ds_read_b64_tr_b16 a[18:19], v34 offset:18432
    ds_read_b64_tr_b16 a[20:21], v35 offset:16384
    buffer_load_dwordx4 v12, s[4:7], s46 offen lds
    v_bfe_u32 v93, v1, 3, 1
    v_cndmask_b32 v90, v91, v90, vcc
    v_mfma_f32_32x32x16_bf16 v[208:223], a[52:55], a[68:71], v[208:223]
    ds_read_b64_tr_b16 a[22:23], v35 offset:18432
    ds_read_b64_tr_b16 a[24:25], v36 offset:16384
    v_bfe_u32 v91, v1, 2, 1
    v_and_b32 v94, 3, v1
    v_lshl_add_u32 v94, v91, 7, v94
    v_lshl_add_u32 v94, v92, 3, v94
    s_waitcnt lgkmcnt(14)
    v_mfma_f32_32x32x16_bf16 v[224:239], a[56:59], a[68:71], v[224:239]
    ds_read_b64_tr_b16 a[26:27], v36 offset:18432
    ds_read_b64_tr_b16 a[28:29], v37 offset:16384
    v_lshl_add_u32 v94, v93, 2, v94
    v_lshlrev_b32 v94, 2, v94
    s_mul_i32 s48, s51, 10
    s_add_u32 s48, s48, s78
    s_lshl_b32 s48, s48, 10
    s_lshl_b32 s49, s36, 7
    v_mfma_f32_32x32x16_bf16 v[240:255], a[60:63], a[68:71], v[240:255]
    s_add_u32 m0, s54, 55296
    ds_read_b64_tr_b16 a[30:31], v37 offset:18432
    buffer_load_dwordx4 v8, s[8:11], s45 offen lds
    s_add_u32 s48, s48, s49
    s_add_u32 s48, s48, 13697024
    s_add_u32 s48, s48, s37
    buffer_store_dword v90, v94, s[12:15], s48 offen sc1
    s_waitcnt lgkmcnt(12)
    v_mfma_f32_32x32x16_bf16 v[128:143], a[0:3], a[64:67], v[128:143]
    ds_read_b128 a[68:71], v49
    ds_read_b64_tr_b16 a[32:33], v30 offset:24576
    ds_read_b64_tr_b16 a[34:35], v30 offset:26624
    s_cmp_eq_u32 s36, 0
    s_cselect_b32 s48, 0, 1073741824
    v_mov_b32 v62, s48
    buffer_load_dword v62, v62, s[16:19], 0 offen sc1
    v_mfma_f32_32x32x16_bf16 v[144:159], a[4:7], a[64:67], v[144:159]
    s_add_u32 m0, s54, 56320
    ds_read_b64_tr_b16 a[36:37], v31 offset:24576
    ds_read_b64_tr_b16 a[38:39], v31 offset:26624
    ds_read_b64_tr_b16 a[40:41], v32 offset:24576
    buffer_load_dwordx4 v9, s[8:11], s45 offen lds
    s_waitcnt lgkmcnt(14)
    v_mfma_f32_32x32x16_bf16 v[160:175], a[8:11], a[64:67], v[160:175]
    ds_read_b64_tr_b16 a[42:43], v32 offset:26624
    ds_read_b64_tr_b16 a[44:45], v33 offset:24576
    v_mfma_f32_32x32x16_bf16 v[176:191], a[12:15], a[64:67], v[176:191]
    ds_read_b64_tr_b16 a[46:47], v33 offset:26624
    ds_read_b64_tr_b16 a[48:49], v34 offset:24576
    s_waitcnt lgkmcnt(14)
    v_mfma_f32_32x32x16_bf16 v[192:207], a[16:19], a[64:67], v[192:207]
    s_add_u32 m0, s55, 84992
    ds_read_b64_tr_b16 a[50:51], v34 offset:26624
    ds_read_b64_tr_b16 a[52:53], v35 offset:24576
    buffer_load_dwordx4 v13, s[4:7], s46 offen lds
    s_add_u32 s44, s44, 1
    s_cmp_eq_u32 s44, 10
    s_cselect_b32 s44, 0, s44
    s_lshl_b32 s46, s44, 7
    s_mul_i32 s45, s44, s43
    v_mfma_f32_32x32x16_bf16 v[208:223], a[20:23], a[64:67], v[208:223]
    ds_read_b64_tr_b16 a[54:55], v35 offset:26624
    ds_read_b64_tr_b16 a[56:57], v36 offset:24576
    s_waitcnt lgkmcnt(14)
    v_mfma_f32_32x32x16_bf16 v[224:239], a[24:27], a[64:67], v[224:239]
    ds_read_b64_tr_b16 a[58:59], v36 offset:26624
    ds_read_b64_tr_b16 a[60:61], v37 offset:24576
    v_mfma_f32_32x32x16_bf16 v[240:255], a[28:31], a[64:67], v[240:255]
    ds_read_b64_tr_b16 a[62:63], v37 offset:26624
    s_waitcnt lgkmcnt(0)
    s_waitcnt vmcnt(18)
    s_barrier
    v_mfma_f32_32x32x16_bf16 v[128:143], a[32:35], a[68:71], v[128:143]
    s_add_u32 m0, s54, 98304
    ds_read_b128 a[64:67], v38
    ds_read_b64_tr_b16 a[0:1], v14 offset:0
    ds_read_b64_tr_b16 a[2:3], v14 offset:2048
    buffer_load_dwordx4 v2, s[8:11], s45 offen lds
    v_cmp_eq_u32 vcc, 0, v0
    v_mov_b32 v118, 1073741824
    v_mfma_f32_32x32x16_bf16 v[144:159], a[36:39], a[68:71], v[144:159]
    ds_read_b64_tr_b16 a[4:5], v15 offset:0
    ds_read_b64_tr_b16 a[6:7], v15 offset:2048
    ds_read_b64_tr_b16 a[8:9], v16 offset:0
    s_lshl_b32 s48, s2, 7
    v_mov_b32 v117, s48
    v_cndmask_b32 v118, v118, v117, vcc
    s_lshl_b32 s48, s39, 3
    s_add_u32 s48, s48, s40
    s_cmp_eq_u32 s42, 1
    s_cselect_b32 s49, 0, 144
    s_add_u32 s48, s48, s49
    s_add_u32 s48, s48, 256
    s_lshl_b32 s48, s48, 7
    v_mov_b32 v117, s48
    v_mfma_f32_32x32x16_bf16 v[160:175], a[40:43], a[68:71], v[160:175]
    ds_read_b64_tr_b16 a[10:11], v16 offset:2048
    ds_read_b64_tr_b16 a[12:13], v17 offset:0
    v_cmp_eq_u32 vcc, 1, v0
    s_nop 1
    v_cndmask_b32 v118, v118, v117, vcc
    s_lshl_b32 s48, s3, 7
    v_mov_b32 v117, s48
    v_mfma_f32_32x32x16_bf16 v[176:191], a[44:47], a[68:71], v[176:191]
    s_add_u32 m0, s54, 99328
    ds_read_b64_tr_b16 a[14:15], v17 offset:2048
    ds_read_b64_tr_b16 a[16:17], v18 offset:0
    buffer_load_dwordx4 v3, s[8:11], s45 offen lds
    v_cmp_eq_u32 vcc, 2, v0
    v_mfma_f32_32x32x16_bf16 v[192:207], a[48:51], a[68:71], v[192:207]
    ds_read_b64_tr_b16 a[18:19], v18 offset:2048
    ds_read_b64_tr_b16 a[20:21], v19 offset:0
    v_cndmask_b32 v118, v118, v117, vcc
    v_mfma_f32_32x32x16_bf16 v[208:223], a[52:55], a[68:71], v[208:223]
    s_add_u32 m0, s55, 131072
    ds_read_b64_tr_b16 a[22:23], v19 offset:2048
    ds_read_b64_tr_b16 a[24:25], v20 offset:0
    buffer_load_dwordx4 v10, s[4:7], s46 offen lds
    v_mfma_f32_32x32x16_bf16 v[224:239], a[56:59], a[68:71], v[224:239]
    ds_read_b64_tr_b16 a[26:27], v20 offset:2048
    ds_read_b64_tr_b16 a[28:29], v21 offset:0
    v_mfma_f32_32x32x16_bf16 v[240:255], a[60:63], a[68:71], v[240:255]
    ds_read_b64_tr_b16 a[30:31], v21 offset:2048
    s_waitcnt lgkmcnt(12)
    v_mfma_f32_32x32x16_bf16 v[128:143], a[0:3], a[64:67], v[128:143]
    s_add_u32 m0, s54, 100352
    ds_read_b128 a[68:71], v39
    ds_read_b64_tr_b16 a[32:33], v14 offset:8192
    ds_read_b64_tr_b16 a[34:35], v14 offset:10240
    buffer_load_dwordx4 v4, s[8:11], s45 offen lds
    v_mfma_f32_32x32x16_bf16 v[144:159], a[4:7], a[64:67], v[144:159]
    ds_read_b64_tr_b16 a[36:37], v15 offset:8192
    ds_read_b64_tr_b16 a[38:39], v15 offset:10240
    ds_read_b64_tr_b16 a[40:41], v16 offset:8192
    s_waitcnt lgkmcnt(14)
    v_mfma_f32_32x32x16_bf16 v[160:175], a[8:11], a[64:67], v[160:175]
    s_add_u32 m0, s54, 101376
    ds_read_b64_tr_b16 a[42:43], v16 offset:10240
    ds_read_b64_tr_b16 a[44:45], v17 offset:8192
    buffer_load_dwordx4 v5, s[8:11], s45 offen lds
    v_mfma_f32_32x32x16_bf16 v[176:191], a[12:15], a[64:67], v[176:191]
    ds_read_b64_tr_b16 a[46:47], v17 offset:10240
    ds_read_b64_tr_b16 a[48:49], v18 offset:8192
    s_waitcnt lgkmcnt(14)
    v_mfma_f32_32x32x16_bf16 v[192:207], a[16:19], a[64:67], v[192:207]
    ds_read_b64_tr_b16 a[50:51], v18 offset:10240
    ds_read_b64_tr_b16 a[52:53], v19 offset:8192
    v_mfma_f32_32x32x16_bf16 v[208:223], a[20:23], a[64:67], v[208:223]
    s_add_u32 m0, s55, 132096
    ds_read_b64_tr_b16 a[54:55], v19 offset:10240
    ds_read_b64_tr_b16 a[56:57], v20 offset:8192
    buffer_load_dwordx4 v11, s[4:7], s46 offen lds
    s_waitcnt lgkmcnt(14)
    v_mfma_f32_32x32x16_bf16 v[224:239], a[24:27], a[64:67], v[224:239]
    ds_read_b64_tr_b16 a[58:59], v20 offset:10240
    ds_read_b64_tr_b16 a[60:61], v21 offset:8192
    v_mfma_f32_32x32x16_bf16 v[240:255], a[28:31], a[64:67], v[240:255]
    s_add_u32 m0, s54, 102400
    ds_read_b64_tr_b16 a[62:63], v21 offset:10240
    buffer_load_dwordx4 v6, s[8:11], s45 offen lds
    s_waitcnt lgkmcnt(12)
    v_mfma_f32_32x32x16_bf16 v[128:143], a[32:35], a[68:71], v[128:143]
    ds_read_b128 a[64:67], v40
    ds_read_b64_tr_b16 a[0:1], v14 offset:16384
    ds_read_b64_tr_b16 a[2:3], v14 offset:18432
    v_mfma_f32_32x32x16_bf16 v[144:159], a[36:39], a[68:71], v[144:159]
    ds_read_b64_tr_b16 a[4:5], v15 offset:16384
    ds_read_b64_tr_b16 a[6:7], v15 offset:18432
    ds_read_b64_tr_b16 a[8:9], v16 offset:16384
    s_waitcnt lgkmcnt(14)
    v_mfma_f32_32x32x16_bf16 v[160:175], a[40:43], a[68:71], v[160:175]
    s_add_u32 m0, s54, 103424
    ds_read_b64_tr_b16 a[10:11], v16 offset:18432
    ds_read_b64_tr_b16 a[12:13], v17 offset:16384
    buffer_load_dwordx4 v7, s[8:11], s45 offen lds
    v_mfma_f32_32x32x16_bf16 v[176:191], a[44:47], a[68:71], v[176:191]
    ds_read_b64_tr_b16 a[14:15], v17 offset:18432
    ds_read_b64_tr_b16 a[16:17], v18 offset:16384
    s_waitcnt lgkmcnt(14)
    v_mfma_f32_32x32x16_bf16 v[192:207], a[48:51], a[68:71], v[192:207]
    s_add_u32 m0, s55, 133120
    ds_read_b64_tr_b16 a[18:19], v18 offset:18432
    ds_read_b64_tr_b16 a[20:21], v19 offset:16384
    buffer_load_dwordx4 v12, s[4:7], s46 offen lds
    v_mfma_f32_32x32x16_bf16 v[208:223], a[52:55], a[68:71], v[208:223]
    ds_read_b64_tr_b16 a[22:23], v19 offset:18432
    ds_read_b64_tr_b16 a[24:25], v20 offset:16384
    s_waitcnt lgkmcnt(14)
    v_mfma_f32_32x32x16_bf16 v[224:239], a[56:59], a[68:71], v[224:239]
    ds_read_b64_tr_b16 a[26:27], v20 offset:18432
    ds_read_b64_tr_b16 a[28:29], v21 offset:16384
    v_mfma_f32_32x32x16_bf16 v[240:255], a[60:63], a[68:71], v[240:255]
    s_add_u32 m0, s54, 104448
    ds_read_b64_tr_b16 a[30:31], v21 offset:18432
    buffer_load_dwordx4 v8, s[8:11], s45 offen lds
    s_waitcnt lgkmcnt(12)
    v_mfma_f32_32x32x16_bf16 v[128:143], a[0:3], a[64:67], v[128:143]
    ds_read_b128 a[68:71], v41
    ds_read_b64_tr_b16 a[32:33], v14 offset:24576
    ds_read_b64_tr_b16 a[34:35], v14 offset:26624
    v_mfma_f32_32x32x16_bf16 v[144:159], a[4:7], a[64:67], v[144:159]
    s_add_u32 m0, s54, 105472
    ds_read_b64_tr_b16 a[36:37], v15 offset:24576
    ds_read_b64_tr_b16 a[38:39], v15 offset:26624
    ds_read_b64_tr_b16 a[40:41], v16 offset:24576
    buffer_load_dwordx4 v9, s[8:11], s45 offen lds
    s_waitcnt lgkmcnt(14)
    v_mfma_f32_32x32x16_bf16 v[160:175], a[8:11], a[64:67], v[160:175]
    ds_read_b64_tr_b16 a[42:43], v16 offset:26624
    ds_read_b64_tr_b16 a[44:45], v17 offset:24576
    v_mfma_f32_32x32x16_bf16 v[176:191], a[12:15], a[64:67], v[176:191]
    ds_read_b64_tr_b16 a[46:47], v17 offset:26624
    ds_read_b64_tr_b16 a[48:49], v18 offset:24576
    s_waitcnt lgkmcnt(14)
    v_mfma_f32_32x32x16_bf16 v[192:207], a[16:19], a[64:67], v[192:207]
    s_add_u32 m0, s55, 134144
    ds_read_b64_tr_b16 a[50:51], v18 offset:26624
    ds_read_b64_tr_b16 a[52:53], v19 offset:24576
    buffer_load_dwordx4 v13, s[4:7], s46 offen lds
    s_add_u32 s44, s44, 1
    s_cmp_eq_u32 s44, 10
    s_cselect_b32 s44, 0, s44
    s_lshl_b32 s46, s44, 7
    s_mul_i32 s45, s44, s43
    v_mfma_f32_32x32x16_bf16 v[208:223], a[20:23], a[64:67], v[208:223]
    ds_read_b64_tr_b16 a[54:55], v19 offset:26624
    ds_read_b64_tr_b16 a[56:57], v20 offset:24576
    s_waitcnt lgkmcnt(14)
    v_mfma_f32_32x32x16_bf16 v[224:239], a[24:27], a[64:67], v[224:239]
    ds_read_b64_tr_b16 a[58:59], v20 offset:26624
    ds_read_b64_tr_b16 a[60:61], v21 offset:24576
    v_mfma_f32_32x32x16_bf16 v[240:255], a[28:31], a[64:67], v[240:255]
    ds_read_b64_tr_b16 a[62:63], v21 offset:26624
    s_waitcnt lgkmcnt(0)
    s_waitcnt vmcnt(12)
    v_readfirstlane_b32 s79, v62
    s_cmp_eq_u32 s36, 0
    s_cbranch_scc0 L1_nok
    s_mov_b32 s49, 0
L1_nchk:
    s_cmp_lg_u32 s79, 0
    s_cbranch_scc1 L1_nok
    s_add_u32 s49, s49, 1
    s_cmp_gt_u32 s49, 30000
    s_cbranch_scc1 L1_nok
    v_mov_b32 v62, 0
    buffer_load_dword v62, v62, s[16:19], 0 offen sc1
    s_waitcnt vmcnt(0)
    v_readfirstlane_b32 s79, v62
    s_branch L1_nchk
L1_nok:
    s_barrier
    v_mfma_f32_32x32x16_bf16 v[128:143], a[32:35], a[68:71], v[128:143]
    s_add_u32 m0, s54, 0
    ds_read_b128 a[64:67], v42
    ds_read_b64_tr_b16 a[0:1], v22 offset:0
    ds_read_b64_tr_b16 a[2:3], v22 offset:2048
    buffer_load_dwordx4 v2, s[8:11], s45 offen lds
    v_mov_b32 v117, s79
    s_mov_b32 s48, 13893632
    buffer_store_dword v117, v118, s[12:15], s48 offen sc1
    v_mfma_f32_32x32x16_bf16 v[144:159], a[36:39], a[68:71], v[144:159]
    ds_read_b64_tr_b16 a[4:5], v23 offset:0
    ds_read_b64_tr_b16 a[6:7], v23 offset:2048
    ds_read_b64_tr_b16 a[8:9], v24 offset:0
    v_mfma_f32_32x32x16_bf16 v[160:175], a[40:43], a[68:71], v[160:175]
    ds_read_b64_tr_b16 a[10:11], v24 offset:2048
    ds_read_b64_tr_b16 a[12:13], v25 offset:0
    v_mfma_f32_32x32x16_bf16 v[176:191], a[44:47], a[68:71], v[176:191]
    s_add_u32 m0, s54, 1024
    ds_read_b64_tr_b16 a[14:15], v25 offset:2048
    ds_read_b64_tr_b16 a[16:17], v26 offset:0
    buffer_load_dwordx4 v3, s[8:11], s45 offen lds
    v_mfma_f32_32x32x16_bf16 v[192:207], a[48:51], a[68:71], v[192:207]
    ds_read_b64_tr_b16 a[18:19], v26 offset:2048
    ds_read_b64_tr_b16 a[20:21], v27 offset:0
    v_mfma_f32_32x32x16_bf16 v[208:223], a[52:55], a[68:71], v[208:223]
    s_add_u32 m0, s55, 32768
    ds_read_b64_tr_b16 a[22:23], v27 offset:2048
    ds_read_b64_tr_b16 a[24:25], v28 offset:0
    buffer_load_dwordx4 v10, s[4:7], s46 offen lds
    v_mfma_f32_32x32x16_bf16 v[224:239], a[56:59], a[68:71], v[224:239]
    ds_read_b64_tr_b16 a[26:27], v28 offset:2048
    ds_read_b64_tr_b16 a[28:29], v29 offset:0
    v_mfma_f32_32x32x16_bf16 v[240:255], a[60:63], a[68:71], v[240:255]
    ds_read_b64_tr_b16 a[30:31], v29 offset:2048
    s_waitcnt lgkmcnt(12)
    v_mfma_f32_32x32x16_bf16 v[128:143], a[0:3], a[64:67], v[128:143]
    s_add_u32 m0, s54, 2048
    ds_read_b128 a[68:71], v43
    ds_read_b64_tr_b16 a[32:33], v22 offset:8192
    ds_read_b64_tr_b16 a[34:35], v22 offset:10240
    buffer_load_dwordx4 v4, s[8:11], s45 offen lds
    v_mfma_f32_32x32x16_bf16 v[144:159], a[4:7], a[64:67], v[144:159]
    ds_read_b64_tr_b16 a[36:37], v23 offset:8192
    ds_read_b64_tr_b16 a[38:39], v23 offset:10240
    ds_read_b64_tr_b16 a[40:41], v24 offset:8192
    s_waitcnt lgkmcnt(14)
    v_mfma_f32_32x32x16_bf16 v[160:175], a[8:11], a[64:67], v[160:175]
    s_add_u32 m0, s54, 3072
    ds_read_b64_tr_b16 a[42:43], v24 offset:10240
    ds_read_b64_tr_b16 a[44:45], v25 offset:8192
    buffer_load_dwordx4 v5, s[8:11], s45 offen lds
    v_mfma_f32_32x32x16_bf16 v[176:191], a[12:15], a[64:67], v[176:191]
    ds_read_b64_tr_b16 a[46:47], v25 offset:10240
    ds_read_b64_tr_b16 a[48:49], v26 offset:8192
    s_waitcnt lgkmcnt(14)
    v_mfma_f32_32x32x16_bf16 v[192:207], a[16:19], a[64:67], v[192:207]
    ds_read_b64_tr_b16 a[50:51], v26 offset:10240
    ds_read_b64_tr_b16 a[52:53], v27 offset:8192
    v_mfma_f32_32x32x16_bf16 v[208:223], a[20:23], a[64:67], v[208:223]
    s_add_u32 m0, s55, 33792
    ds_read_b64_tr_b16 a[54:55], v27 offset:10240
    ds_read_b64_tr_b16 a[56:57], v28 offset:8192
    buffer_load_dwordx4 v11, s[4:7], s46 offen lds
    s_waitcnt lgkmcnt(14)
    v_mfma_f32_32x32x16_bf16 v[224:239], a[24:27], a[64:67], v[224:239]
    ds_read_b64_tr_b16 a[58:59], v28 offset:10240
    ds_read_b64_tr_b16 a[60:61], v29 offset:8192
    v_mfma_f32_32x32x16_bf16 v[240:255], a[28:31], a[64:67], v[240:255]
    s_add_u32 m0, s54, 4096
    ds_read_b64_tr_b16 a[62:63], v29 offset:10240
    buffer_load_dwordx4 v6, s[8:11], s45 offen lds
    s_waitcnt lgkmcnt(12)
    v_mfma_f32_32x32x16_bf16 v[128:143], a[32:35], a[68:71], v[128:143]
    ds_read_b128 a[64:67], v44
    ds_read_b64_tr_b16 a[0:1], v22 offset:16384
    ds_read_b64_tr_b16 a[2:3], v22 offset:18432
    v_mfma_f32_32x32x16_bf16 v[144:159], a[36:39], a[68:71], v[144:159]
    ds_read_b64_tr_b16 a[4:5], v23 offset:16384
    ds_read_b64_tr_b16 a[6:7], v23 offset:18432
    ds_read_b64_tr_b16 a[8:9], v24 offset:16384
    s_waitcnt lgkmcnt(14)
    v_mfma_f32_32x32x16_bf16 v[160:175], a[40:43], a[68:71], v[160:175]
    s_add_u32 m0, s54, 5120
    ds_read_b64_tr_b16 a[10:11], v24 offset:18432
    ds_read_b64_tr_b16 a[12:13], v25 offset:16384
    buffer_load_dwordx4 v7, s[8:11], s45 offen lds
    v_mfma_f32_32x32x16_bf16 v[176:191], a[44:47], a[68:71], v[176:191]
    ds_read_b64_tr_b16 a[14:15], v25 offset:18432
    ds_read_b64_tr_b16 a[16:17], v26 offset:16384
    s_waitcnt lgkmcnt(14)
    v_mfma_f32_32x32x16_bf16 v[192:207], a[48:51], a[68:71], v[192:207]
    s_add_u32 m0, s55, 34816
    ds_read_b64_tr_b16 a[18:19], v26 offset:18432
    ds_read_b64_tr_b16 a[20:21], v27 offset:16384
    buffer_load_dwordx4 v12, s[4:7], s46 offen lds
    v_mfma_f32_32x32x16_bf16 v[208:223], a[52:55], a[68:71], v[208:223]
    ds_read_b64_tr_b16 a[22:23], v27 offset:18432
    ds_read_b64_tr_b16 a[24:25], v28 offset:16384
    s_waitcnt lgkmcnt(14)
    v_mfma_f32_32x32x16_bf16 v[224:239], a[56:59], a[68:71], v[224:239]
    ds_read_b64_tr_b16 a[26:27], v28 offset:18432
    ds_read_b64_tr_b16 a[28:29], v29 offset:16384
    v_mfma_f32_32x32x16_bf16 v[240:255], a[60:63], a[68:71], v[240:255]
    s_add_u32 m0, s54, 6144
    ds_read_b64_tr_b16 a[30:31], v29 offset:18432
    buffer_load_dwordx4 v8, s[8:11], s45 offen lds
    s_waitcnt lgkmcnt(12)
    v_mfma_f32_32x32x16_bf16 v[128:143], a[0:3], a[64:67], v[128:143]
    ds_read_b128 a[68:71], v45
    ds_read_b64_tr_b16 a[32:33], v22 offset:24576
    ds_read_b64_tr_b16 a[34:35], v22 offset:26624
    v_mfma_f32_32x32x16_bf16 v[144:159], a[4:7], a[64:67], v[144:159]
    s_add_u32 m0, s54, 7168
    ds_read_b64_tr_b16 a[36:37], v23 offset:24576
    ds_read_b64_tr_b16 a[38:39], v23 offset:26624
    ds_read_b64_tr_b16 a[40:41], v24 offset:24576
    buffer_load_dwordx4 v9, s[8:11], s45 offen lds
    s_waitcnt lgkmcnt(14)
    v_mfma_f32_32x32x16_bf16 v[160:175], a[8:11], a[64:67], v[160:175]
    ds_read_b64_tr_b16 a[42:43], v24 offset:26624
    ds_read_b64_tr_b16 a[44:45], v25 offset:24576
    v_mfma_f32_32x32x16_bf16 v[176:191], a[12:15], a[64:67], v[176:191]
    ds_read_b64_tr_b16 a[46:47], v25 offset:26624
    ds_read_b64_tr_b16 a[48:49], v26 offset:24576
    s_waitcnt lgkmcnt(14)
    v_mfma_f32_32x32x16_bf16 v[192:207], a[16:19], a[64:67], v[192:207]
    s_add_u32 m0, s55, 35840
    ds_read_b64_tr_b16 a[50:51], v26 offset:26624
    ds_read_b64_tr_b16 a[52:53], v27 offset:24576
    buffer_load_dwordx4 v13, s[4:7], s46 offen lds
    s_add_u32 s44, s44, 1
    s_cmp_eq_u32 s44, 10
    s_cselect_b32 s44, 0, s44
    s_lshl_b32 s46, s44, 7
    s_mul_i32 s45, s44, s43
    v_mfma_f32_32x32x16_bf16 v[208:223], a[20:23], a[64:67], v[208:223]
    ds_read_b64_tr_b16 a[54:55], v27 offset:26624
    ds_read_b64_tr_b16 a[56:57], v28 offset:24576
    s_waitcnt lgkmcnt(14)
    v_mfma_f32_32x32x16_bf16 v[224:239], a[24:27], a[64:67], v[224:239]
    ds_read_b64_tr_b16 a[58:59], v28 offset:26624
    ds_read_b64_tr_b16 a[60:61], v29 offset:24576
    v_mfma_f32_32x32x16_bf16 v[240:255], a[28:31], a[64:67], v[240:255]
    ds_read_b64_tr_b16 a[62:63], v29 offset:26624
    s_waitcnt lgkmcnt(0)
    s_waitcnt vmcnt(13)
    s_barrier
    v_mfma_f32_32x32x16_bf16 v[128:143], a[32:35], a[68:71], v[128:143]
    s_add_u32 m0, s54, 49152
    ds_read_b128 a[64:67], v46
    ds_read_b64_tr_b16 a[0:1], v30 offset:0
    ds_read_b64_tr_b16 a[2:3], v30 offset:2048
    buffer_load_dwordx4 v2, s[8:11], s45 offen lds
    s_bfe_u32 s48, s2, 196611
    s_mul_i32 s48, s48, 5
    s_add_u32 s49, s48, 4
    s_lshr_b32 s48, s48, 3
    s_lshr_b32 s49, s49, 3
    v_min_u32 v119, 36, v1
    v_mov_b32 v124, 544
    v_mad_u32_u24 v119, v119, 5, v124
    v_add_u32 v124, s48, v119
    v_add_u32 v119, s49, v119
    v_mfma_f32_32x32x16_bf16 v[144:159], a[36:39], a[68:71], v[144:159]
    ds_read_b64_tr_b16 a[4:5], v31 offset:0
    ds_read_b64_tr_b16 a[6:7], v31 offset:2048
    ds_read_b64_tr_b16 a[8:9], v32 offset:0
    s_lshr_b32 s48, s41, 3
    s_sub_u32 s48, s48, 37
    v_add_u32 v116, s48, v1
    v_min_u32 v116, 255, v116
    v_mfma_f32_32x32x16_bf16 v[160:175], a[40:43], a[68:71], v[160:175]
    ds_read_b64_tr_b16 a[10:11], v32 offset:2048
    ds_read_b64_tr_b16 a[12:13], v33 offset:0
    v_cmp_lt_u32 vcc, 36, v1
    s_nop 1
    v_cndmask_b32 v124, v124, v116, vcc
    s_cmp_eq_u32 s42, 1
    s_cselect_b32 s49, 0, 144
    s_add_u32 s49, s49, s40
    s_add_u32 s49, s49, -176
    v_lshl_add_u32 v116, v1, 3, s49
    v_mfma_f32_32x32x16_bf16 v[176:191], a[44:47], a[68:71], v[176:191]
    s_add_u32 m0, s54, 50176
    ds_read_b64_tr_b16 a[14:15], v33 offset:2048
    ds_read_b64_tr_b16 a[16:17], v34 offset:0
    buffer_load_dwordx4 v3, s[8:11], s45 offen lds
    v_cmp_lt_u32 vcc, 53, v1
    v_mfma_f32_32x32x16_bf16 v[192:207], a[48:51], a[68:71], v[192:207]
    ds_read_b64_tr_b16 a[18:19], v34 offset:2048
    ds_read_b64_tr_b16 a[20:21], v35 offset:0
    v_cndmask_b32 v124, v124, v116, vcc
    s_cmp_eq_u32 s36, 0
    s_cselect_b32 s48, 0, 1073741824
    v_lshl_add_u32 v124, v124, 7, s48
    v_lshl_add_u32 v119, v119, 7, s48
    v_mfma_f32_32x32x16_bf16 v[208:223], a[52:55], a[68:71], v[208:223]
    s_add_u32 m0, s55, 81920
    ds_read_b64_tr_b16 a[22:23], v35 offset:2048
    ds_read_b64_tr_b16 a[24:25], v36 offset:0
    buffer_load_dwordx4 v10, s[4:7], s46 offen lds
    s_and_b32 s48, s2, 7
    s_lshl_b32 s48, s48, 2
    s_lshr_b32 s56, s2, 6
    s_add_u32 s56, s56, s48
    v_mfma_f32_32x32x16_bf16 v[224:239], a[56:59], a[68:71], v[224:239]
    ds_read_b64_tr_b16 a[26:27], v36 offset:2048
    ds_read_b64_tr_b16 a[28:29], v37 offset:0
    s_bfe_u32 s57, s2, 196611
    s_mul_i32 s48, s57, 378880
    s_add_u32 s48, s48, 10485760
    v_lshlrev_b32 v125, 4, v1
    v_mfma_f32_32x32x16_bf16 v[240:255], a[60:63], a[68:71], v[240:255]
    ds_read_b64_tr_b16 a[30:31], v37 offset:2048
    v_add_u32 v125, s48, v125
    s_mul_i32 s63, s36, 14
    s_cmp_eq_u32 s36, 3
    s_cselect_b32 s63, 41, s63
    s_waitcnt lgkmcnt(12)
    v_mfma_f32_32x32x16_bf16 v[128:143], a[0:3], a[64:67], v[128:143]
    s_add_u32 m0, s54, 51200
    ds_read_b128 a[68:71], v47
    ds_read_b64_tr_b16 a[32:33], v30 offset:8192
    ds_read_b64_tr_b16 a[34:35], v30 offset:10240
    buffer_load_dwordx4 v4, s[8:11], s45 offen lds
    s_add_u32 s63, s63, 20
    s_lshr_b32 s48, s2, 6
    s_add_u32 s58, s57, s48
    s_mul_i32 s48, s48, 7
    v_mfma_f32_32x32x16_bf16 v[144:159], a[4:7], a[64:67], v[144:159]
    ds_read_b64_tr_b16 a[36:37], v31 offset:8192
    ds_read_b64_tr_b16 a[38:39], v31 offset:10240
    ds_read_b64_tr_b16 a[40:41], v32 offset:8192
    s_lshr_b32 s48, s48, 1
    s_mul_i32 s49, s57, 7
    s_lshr_b32 s49, s49, 2
    s_add_u32 s59, s48, s49
    s_waitcnt lgkmcnt(14)
    v_mfma_f32_32x32x16_bf16 v[160:175], a[8:11], a[64:67], v[160:175]
    s_add_u32 m0, s54, 52224
    ds_read_b64_tr_b16 a[42:43], v32 offset:10240
    ds_read_b64_tr_b16 a[44:45], v33 offset:8192
    buffer_load_dwordx4 v5, s[8:11], s45 offen lds
    s_cmp_ge_u32 s59, 14
    s_cselect_b32 s48, 14, 0
    s_sub_u32 s59, s59, s48
    s_mul_i32 s48, s58, 52
    v_mfma_f32_32x32x16_bf16 v[176:191], a[12:15], a[64:67], v[176:191]
    ds_read_b64_tr_b16 a[46:47], v33 offset:10240
    ds_read_b64_tr_b16 a[48:49], v34 offset:8192
    s_lshr_b32 s48, s48, 8
    s_mul_i32 s48, s48, 5
    s_sub_u32 s58, s58, s48
    v_add_u32 v126, 4096, v125
    s_waitcnt lgkmcnt(14)
    v_mfma_f32_32x32x16_bf16 v[192:207], a[16:19], a[64:67], v[192:207]
    ds_read_b64_tr_b16 a[50:51], v34 offset:10240
    ds_read_b64_tr_b16 a[52:53], v35 offset:8192
    s_mul_i32 s68, s36, 10240
    s_mul_i32 s69, s36, 15360
    s_add_u32 s69, s69, 49152
    s_cmp_ge_u32 s36, 2
    s_cselect_b32 s64, 13, 14
    s_mul_i32 s60, s36, 5
    s_mov_b32 s58, 0
    s_mov_b32 s59, 0
    v_mfma_f32_32x32x16_bf16 v[208:223], a[20:23], a[64:67], v[208:223]
    s_add_u32 m0, s55, 82944
    ds_read_b64_tr_b16 a[54:55], v35 offset:10240
    ds_read_b64_tr_b16 a[56:57], v36 offset:8192
    buffer_load_dwordx4 v11, s[4:7], s46 offen lds
    s_waitcnt lgkmcnt(14)
    v_mfma_f32_32x32x16_bf16 v[224:239], a[24:27], a[64:67], v[224:239]
    ds_read_b64_tr_b16 a[58:59], v36 offset:10240
    ds_read_b64_tr_b16 a[60:61], v37 offset:8192
    v_mfma_f32_32x32x16_bf16 v[240:255], a[28:31], a[64:67], v[240:255]
    s_add_u32 m0, s54, 53248
    ds_read_b64_tr_b16 a[62:63], v37 offset:10240
    buffer_load_dwordx4 v6, s[8:11], s45 offen lds
    s_waitcnt lgkmcnt(12)
    v_mfma_f32_32x32x16_bf16 v[128:143], a[32:35], a[68:71], v[128:143]
    ds_read_b128 a[64:67], v48
    ds_read_b64_tr_b16 a[0:1], v30 offset:16384
    ds_read_b64_tr_b16 a[2:3], v30 offset:18432
    v_mfma_f32_32x32x16_bf16 v[144:159], a[36:39], a[68:71], v[144:159]
    ds_read_b64_tr_b16 a[4:5], v31 offset:16384
    ds_read_b64_tr_b16 a[6:7], v31 offset:18432
    ds_read_b64_tr_b16 a[8:9], v32 offset:16384
    s_waitcnt lgkmcnt(14)
    v_mfma_f32_32x32x16_bf16 v[160:175], a[40:43], a[68:71], v[160:175]
    s_add_u32 m0, s54, 54272
    ds_read_b64_tr_b16 a[10:11], v32 offset:18432
    ds_read_b64_tr_b16 a[12:13], v33 offset:16384
    buffer_load_dwordx4 v7, s[8:11], s45 offen lds
    v_mfma_f32_32x32x16_bf16 v[176:191], a[44:47], a[68:71], v[176:191]
    ds_read_b64_tr_b16 a[14:15], v33 offset:18432
    ds_read_b64_tr_b16 a[16:17], v34 offset:16384
    s_waitcnt lgkmcnt(14)
    v_mfma_f32_32x32x16_bf16 v[192:207], a[48:51], a[68:71], v[192:207]
    s_add_u32 m0, s55, 83968
    ds_read_b64_tr_b16 a[18:19], v34 offset:18432
    ds_read_b64_tr_b16 a[20:21], v35 offset:16384
    buffer_load_dwordx4 v12, s[4:7], s46 offen lds
    v_mfma_f32_32x32x16_bf16 v[208:223], a[52:55], a[68:71], v[208:223]
    ds_read_b64_tr_b16 a[22:23], v35 offset:18432
    ds_read_b64_tr_b16 a[24:25], v36 offset:16384
    s_waitcnt lgkmcnt(14)
    v_mfma_f32_32x32x16_bf16 v[224:239], a[56:59], a[68:71], v[224:239]
    ds_read_b64_tr_b16 a[26:27], v36 offset:18432
    ds_read_b64_tr_b16 a[28:29], v37 offset:16384
    v_mfma_f32_32x32x16_bf16 v[240:255], a[60:63], a[68:71], v[240:255]
    s_add_u32 m0, s54, 55296
    ds_read_b64_tr_b16 a[30:31], v37 offset:18432
    buffer_load_dwordx4 v8, s[8:11], s45 offen lds
    s_waitcnt lgkmcnt(12)
    v_mfma_f32_32x32x16_bf16 v[128:143], a[0:3], a[64:67], v[128:143]
    ds_read_b128 a[68:71], v49
    ds_read_b64_tr_b16 a[32:33], v30 offset:24576
    ds_read_b64_tr_b16 a[34:35], v30 offset:26624
    v_mfma_f32_32x32x16_bf16 v[144:159], a[4:7], a[64:67], v[144:159]
    s_add_u32 m0, s54, 56320
    ds_read_b64_tr_b16 a[36:37], v31 offset:24576
    ds_read_b64_tr_b16 a[38:39], v31 offset:26624
    ds_read_b64_tr_b16 a[40:41], v32 offset:24576
    buffer_load_dwordx4 v9, s[8:11], s45 offen lds
    s_waitcnt lgkmcnt(14)
    v_mfma_f32_32x32x16_bf16 v[160:175], a[8:11], a[64:67], v[160:175]
    ds_read_b64_tr_b16 a[42:43], v32 offset:26624
    ds_read_b64_tr_b16 a[44:45], v33 offset:24576
    v_mfma_f32_32x32x16_bf16 v[176:191], a[12:15], a[64:67], v[176:191]
    ds_read_b64_tr_b16 a[46:47], v33 offset:26624
    ds_read_b64_tr_b16 a[48:49], v34 offset:24576
    s_waitcnt lgkmcnt(14)
    v_mfma_f32_32x32x16_bf16 v[192:207], a[16:19], a[64:67], v[192:207]
    s_add_u32 m0, s55, 84992
    ds_read_b64_tr_b16 a[50:51], v34 offset:26624
    ds_read_b64_tr_b16 a[52:53], v35 offset:24576
    buffer_load_dwordx4 v13, s[4:7], s46 offen lds
    s_add_u32 s44, s44, 1
    s_cmp_eq_u32 s44, 10
    s_cselect_b32 s44, 0, s44
    s_lshl_b32 s46, s44, 7
    s_mul_i32 s45, s44, s43
    v_mfma_f32_32x32x16_bf16 v[208:223], a[20:23], a[64:67], v[208:223]
    ds_read_b64_tr_b16 a[54:55], v35 offset:26624
    ds_read_b64_tr_b16 a[56:57], v36 offset:24576
    s_waitcnt lgkmcnt(14)
    v_mfma_f32_32x32x16_bf16 v[224:239], a[24:27], a[64:67], v[224:239]
    ds_read_b64_tr_b16 a[58:59], v36 offset:26624
    ds_read_b64_tr_b16 a[60:61], v37 offset:24576
    v_mfma_f32_32x32x16_bf16 v[240:255], a[28:31], a[64:67], v[240:255]
    ds_read_b64_tr_b16 a[62:63], v37 offset:26624
    s_waitcnt lgkmcnt(0)
    s_waitcnt vmcnt(12)
    s_barrier
    v_mfma_f32_32x32x16_bf16 v[128:143], a[32:35], a[68:71], v[128:143]
    s_add_u32 m0, s54, 98304
    ds_read_b128 a[64:67], v38
    ds_read_b64_tr_b16 a[0:1], v14 offset:0
    ds_read_b64_tr_b16 a[2:3], v14 offset:2048
    buffer_load_dwordx4 v2, s[8:11], s45 offen lds
    s_mov_b32 s50, 13893632
    buffer_load_dword v56, v124, s[12:15], s50 offen sc1
    v_mfma_f32_32x32x16_bf16 v[144:159], a[36:39], a[68:71], v[144:159]
    ds_read_b64_tr_b16 a[4:5], v15 offset:0
    ds_read_b64_tr_b16 a[6:7], v15 offset:2048
    ds_read_b64_tr_b16 a[8:9], v16 offset:0
    s_mov_b32 s50, 13893632
    buffer_load_dword v57, v119, s[12:15], s50 offen sc1
    v_and_b32 v117, 15, v1
    v_lshrrev_b32 v118, 4, v1
    v_mfma_f32_32x32x16_bf16 v[160:175], a[40:43], a[68:71], v[160:175]
    ds_read_b64_tr_b16 a[10:11], v16 offset:2048
    ds_read_b64_tr_b16 a[12:13], v17 offset:0
    s_mul_i32 s48, s57, 160
    v_lshl_add_u32 v118, v118, 3, s48
    v_min_u32 v117, 9, v117
    v_lshrrev_b32 v115, 1, v117
    v_mfma_f32_32x32x16_bf16 v[176:191], a[44:47], a[68:71], v[176:191]
    s_add_u32 m0, s54, 99328
    ds_read_b64_tr_b16 a[14:15], v17 offset:2048
    ds_read_b64_tr_b16 a[16:17], v18 offset:0
    buffer_load_dwordx4 v3, s[8:11], s45 offen lds
    v_and_b32 v117, 1, v117
    v_lshl_add_u32 v118, v115, 5, v118
    v_mfma_f32_32x32x16_bf16 v[192:207], a[48:51], a[68:71], v[192:207]
    ds_read_b64_tr_b16 a[18:19], v18 offset:2048
    ds_read_b64_tr_b16 a[20:21], v19 offset:0
    v_lshl_add_u32 v118, v117, 2, v118
    v_mul_u32_u24 v116, 6554, v1
    v_lshrrev_b32 v116, 16, v116
    v_mul_u32_u24 v116, 1120, v116
    v_mfma_f32_32x32x16_bf16 v[208:223], a[52:55], a[68:71], v[208:223]
    s_add_u32 m0, s55, 131072
    ds_read_b64_tr_b16 a[22:23], v19 offset:2048
    ds_read_b64_tr_b16 a[24:25], v20 offset:0
    buffer_load_dwordx4 v10, s[4:7], s46 offen lds
    v_lshl_add_u32 v116, v1, 4, v116
    v_add_u32 v117, 64, v1
    v_mfma_f32_32x32x16_bf16 v[224:239], a[56:59], a[68:71], v[224:239]
    ds_read_b64_tr_b16 a[26:27], v20 offset:2048
    ds_read_b64_tr_b16 a[28:29], v21 offset:0
    v_mul_u32_u24 v117, 6554, v117
    v_lshrrev_b32 v117, 16, v117
    v_mul_u32_u24 v117, 1120, v117
    v_lshl_add_u32 v117, v1, 4, v117
    v_mfma_f32_32x32x16_bf16 v[240:255], a[60:63], a[68:71], v[240:255]
    ds_read_b64_tr_b16 a[30:31], v21 offset:2048
    v_add_u32 v115, 256, v1
    v_mul_u32_u24 v115, 3277, v115
    v_lshrrev_b32 v115, 16, v115
    v_mul_u32_u24 v115, 1120, v115
    s_waitcnt lgkmcnt(12)
    v_mfma_f32_32x32x16_bf16 v[128:143], a[0:3], a[64:67], v[128:143]
    s_add_u32 m0, s54, 100352
    ds_read_b128 a[68:71], v39
    ds_read_b64_tr_b16 a[32:33], v14 offset:8192
    ds_read_b64_tr_b16 a[34:35], v14 offset:10240
    buffer_load_dwordx4 v4, s[8:11], s45 offen lds
    v_lshl_add_u32 v115, v1, 3, v115
    s_lshl_b32 s48, s56, 2
    s_add_u32 s48, s48, s36
    s_lshl_b32 s48, s48, 7
    s_add_u32 s48, s48, s57
    s_mul_i32 s48, s48, 160
    v_add_u32 v116, s48, v116
    v_add_u32 v117, s48, v117
    v_add_u32 v115, s48, v115
    v_mfma_f32_32x32x16_bf16 v[144:159], a[4:7], a[64:67], v[144:159]
    ds_read_b64_tr_b16 a[36:37], v15 offset:8192
    ds_read_b64_tr_b16 a[38:39], v15 offset:10240
    ds_read_b64_tr_b16 a[40:41], v16 offset:8192
    s_mov_b32 s32, s70
    s_mov_b32 s33, s71
    s_mov_b32 s34, 1280
    s_mov_b32 s35, 0x20000
    s_waitcnt lgkmcnt(14)
    v_mfma_f32_32x32x16_bf16 v[160:175], a[8:11], a[64:67], v[160:175]
    s_add_u32 m0, s54, 101376
    ds_read_b64_tr_b16 a[42:43], v16 offset:10240
    ds_read_b64_tr_b16 a[44:45], v17 offset:8192
    buffer_load_dwordx4 v5, s[8:11], s45 offen lds
    v_mfma_f32_32x32x16_bf16 v[176:191], a[12:15], a[64:67], v[176:191]
    ds_read_b64_tr_b16 a[46:47], v17 offset:10240
    ds_read_b64_tr_b16 a[48:49], v18 offset:8192
    s_waitcnt lgkmcnt(14)
    v_mfma_f32_32x32x16_bf16 v[192:207], a[16:19], a[64:67], v[192:207]
    ds_read_b64_tr_b16 a[50:51], v18 offset:10240
    ds_read_b64_tr_b16 a[52:53], v19 offset:8192
    v_mfma_f32_32x32x16_bf16 v[208:223], a[20:23], a[64:67], v[208:223]
    s_add_u32 m0, s55, 132096
    ds_read_b64_tr_b16 a[54:55], v19 offset:10240
    ds_read_b64_tr_b16 a[56:57], v20 offset:8192
    buffer_load_dwordx4 v11, s[4:7], s46 offen lds
    s_waitcnt lgkmcnt(14)
    v_mfma_f32_32x32x16_bf16 v[224:239], a[24:27], a[64:67], v[224:239]
    ds_read_b64_tr_b16 a[58:59], v20 offset:10240
    ds_read_b64_tr_b16 a[60:61], v21 offset:8192
    v_mfma_f32_32x32x16_bf16 v[240:255], a[28:31], a[64:67], v[240:255]
    s_add_u32 m0, s54, 102400
    ds_read_b64_tr_b16 a[62:63], v21 offset:10240
    buffer_load_dwordx4 v6, s[8:11], s45 offen lds
    s_waitcnt lgkmcnt(12)
    v_mfma_f32_32x32x16_bf16 v[128:143], a[32:35], a[68:71], v[128:143]
    ds_read_b128 a[64:67], v40
    ds_read_b64_tr_b16 a[0:1], v14 offset:16384
    ds_read_b64_tr_b16 a[2:3], v14 offset:18432
    v_mfma_f32_32x32x16_bf16 v[144:159], a[36:39], a[68:71], v[144:159]
    ds_read_b64_tr_b16 a[4:5], v15 offset:16384
    ds_read_b64_tr_b16 a[6:7], v15 offset:18432
    ds_read_b64_tr_b16 a[8:9], v16 offset:16384
    s_waitcnt lgkmcnt(14)
    v_mfma_f32_32x32x16_bf16 v[160:175], a[40:43], a[68:71], v[160:175]
    s_add_u32 m0, s54, 103424
    ds_read_b64_tr_b16 a[10:11], v16 offset:18432
    ds_read_b64_tr_b16 a[12:13], v17 offset:16384
    buffer_load_dwordx4 v7, s[8:11], s45 offen lds
    v_mfma_f32_32x32x16_bf16 v[176:191], a[44:47], a[68:71], v[176:191]
    ds_read_b64_tr_b16 a[14:15], v17 offset:18432
    ds_read_b64_tr_b16 a[16:17], v18 offset:16384
    s_waitcnt lgkmcnt(14)
    v_mfma_f32_32x32x16_bf16 v[192:207], a[48:51], a[68:71], v[192:207]
    s_add_u32 m0, s55, 133120
    ds_read_b64_tr_b16 a[18:19], v18 offset:18432
    ds_read_b64_tr_b16 a[20:21], v19 offset:16384
    buffer_load_dwordx4 v12, s[4:7], s46 offen lds
    v_mfma_f32_32x32x16_bf16 v[208:223], a[52:55], a[68:71], v[208:223]
    ds_read_b64_tr_b16 a[22:23], v19 offset:18432
    ds_read_b64_tr_b16 a[24:25], v20 offset:16384
    s_waitcnt lgkmcnt(14)
    v_mfma_f32_32x32x16_bf16 v[224:239], a[56:59], a[68:71], v[224:239]
    ds_read_b64_tr_b16 a[26:27], v20 offset:18432
    ds_read_b64_tr_b16 a[28:29], v21 offset:16384
    v_mfma_f32_32x32x16_bf16 v[240:255], a[60:63], a[68:71], v[240:255]
    s_add_u32 m0, s54, 104448
    ds_read_b64_tr_b16 a[30:31], v21 offset:18432
    buffer_load_dwordx4 v8, s[8:11], s45 offen lds
    s_waitcnt lgkmcnt(12)
    v_mfma_f32_32x32x16_bf16 v[128:143], a[0:3], a[64:67], v[128:143]
    ds_read_b128 a[68:71], v41
    ds_read_b64_tr_b16 a[32:33], v14 offset:24576
    ds_read_b64_tr_b16 a[34:35], v14 offset:26624
    v_mfma_f32_32x32x16_bf16 v[144:159], a[4:7], a[64:67], v[144:159]
    s_add_u32 m0, s54, 105472
    ds_read_b64_tr_b16 a[36:37], v15 offset:24576
    ds_read_b64_tr_b16 a[38:39], v15 offset:26624
    ds_read_b64_tr_b16 a[40:41], v16 offset:24576
    buffer_load_dwordx4 v9, s[8:11], s45 offen lds
    s_waitcnt lgkmcnt(14)
    v_mfma_f32_32x32x16_bf16 v[160:175], a[8:11], a[64:67], v[160:175]
    ds_read_b64_tr_b16 a[42:43], v16 offset:26624
    ds_read_b64_tr_b16 a[44:45], v17 offset:24576
    v_mfma_f32_32x32x16_bf16 v[176:191], a[12:15], a[64:67], v[176:191]
    ds_read_b64_tr_b16 a[46:47], v17 offset:26624
    ds_read_b64_tr_b16 a[48:49], v18 offset:24576
    s_waitcnt lgkmcnt(14)
    v_mfma_f32_32x32x16_bf16 v[192:207], a[16:19], a[64:67], v[192:207]
    s_add_u32 m0, s55, 134144
    ds_read_b64_tr_b16 a[50:51], v18 offset:26624
    ds_read_b64_tr_b16 a[52:53], v19 offset:24576
    buffer_load_dwordx4 v13, s[4:7], s46 offen lds
    s_add_u32 s44, s44, 1
    s_cmp_eq_u32 s44, 10
    s_cselect_b32 s44, 0, s44
    s_lshl_b32 s46, s44, 7
    s_mul_i32 s45, s44, s43
    v_mfma_f32_32x32x16_bf16 v[208:223], a[20:23], a[64:67], v[208:223]
    ds_read_b64_tr_b16 a[54:55], v19 offset:26624
    ds_read_b64_tr_b16 a[56:57], v20 offset:24576
    s_waitcnt lgkmcnt(14)
    v_mfma_f32_32x32x16_bf16 v[224:239], a[24:27], a[64:67], v[224:239]
    ds_read_b64_tr_b16 a[58:59], v20 offset:26624
    ds_read_b64_tr_b16 a[60:61], v21 offset:24576
    v_mfma_f32_32x32x16_bf16 v[240:255], a[28:31], a[64:67], v[240:255]
    ds_read_b64_tr_b16 a[62:63], v21 offset:26624
    s_waitcnt lgkmcnt(0)
    s_waitcnt vmcnt(14)
    s_waitcnt vmcnt(11)
    s_cmp_eq_u32 s36, 0
    s_cbranch_scc0 L1_p1_ok
    s_mov_b32 s49, 0
L1_p1_chk:
    v_xor_b32 v56, s79, v56
    v_xor_b32 v57, s79, v57
    v_or_b32 v56, v56, v57
    v_cmp_ne_u32 vcc, 0, v56
    s_cbranch_vccz L1_p1_ok
    s_add_u32 s49, s49, 1
    s_cmp_gt_u32 s49, 30000
    s_cbranch_scc1 L1_p1_ok
    s_mov_b32 s50, 13893632
    buffer_load_dword v56, v124, s[12:15], s50 offen sc1
    s_mov_b32 s50, 13893632
    buffer_load_dword v57, v119, s[12:15], s50 offen sc1
    s_waitcnt vmcnt(0)
    s_branch L1_p1_chk
L1_p1_ok:
    s_barrier
    v_mfma_f32_32x32x16_bf16 v[128:143], a[32:35], a[68:71], v[128:143]
    s_add_u32 m0, s54, 0
    ds_read_b128 a[64:67], v42
    ds_read_b64_tr_b16 a[0:1], v22 offset:0
    ds_read_b64_tr_b16 a[2:3], v22 offset:2048
    buffer_load_dwordx4 v2, s[8:11], s45 offen lds
    s_lshl_b32 s48, s36, 5
    s_add_u32 s48, s48, s41
    v_and_b32 v56, 31, v1
    v_mfma_f32_32x32x16_bf16 v[144:159], a[36:39], a[68:71], v[144:159]
    ds_read_b64_tr_b16 a[4:5], v23 offset:0
    ds_read_b64_tr_b16 a[6:7], v23 offset:2048
    ds_read_b64_tr_b16 a[8:9], v24 offset:0
    v_add_u32 v56, s48, v56
    v_lshlrev_b32 v56, 3, v56
    s_mov_b32 s48, 13631488
    buffer_load_dwordx2 v[56:57], v56, s[12:15], s48 offen sc1
    v_mfma_f32_32x32x16_bf16 v[160:175], a[40:43], a[68:71], v[160:175]
    ds_read_b64_tr_b16 a[10:11], v24 offset:2048
    ds_read_b64_tr_b16 a[12:13], v25 offset:0
    s_mul_i32 s48, s51, 10240
    s_add_u32 s48, s48, 13697024
    v_lshlrev_b32 v59, 2, v0
    buffer_load_dword v60, v59, s[12:15], s48 offen offset:0 sc1
    v_mfma_f32_32x32x16_bf16 v[176:191], a[44:47], a[68:71], v[176:191]
    s_add_u32 m0, s54, 1024
    ds_read_b64_tr_b16 a[14:15], v25 offset:2048
    ds_read_b64_tr_b16 a[16:17], v26 offset:0
    buffer_load_dwordx4 v3, s[8:11], s45 offen lds
    buffer_load_dword v61, v59, s[12:15], s48 offen offset:1024 sc1
    buffer_load_dword v62, v59, s[12:15], s48 offen offset:2048 sc1
    v_mfma_f32_32x32x16_bf16 v[192:207], a[48:51], a[68:71], v[192:207]
    ds_read_b64_tr_b16 a[18:19], v26 offset:2048
    ds_read_b64_tr_b16 a[20:21], v27 offset:0
    buffer_load_dword v63, v59, s[12:15], s48 offen offset:3072 sc1
    s_add_u32 s48, s48, 4096
    buffer_load_dword v64, v59, s[12:15], s48 offen offset:0 sc1
    buffer_load_dword v65, v59, s[12:15], s48 offen offset:1024 sc1
    v_mfma_f32_32x32x16_bf16 v[208:223], a[52:55], a[68:71], v[208:223]
    s_add_u32 m0, s55, 32768
    ds_read_b64_tr_b16 a[22:23], v27 offset:2048
    ds_read_b64_tr_b16 a[24:25], v28 offset:0
    buffer_load_dwordx4 v10, s[4:7], s46 offen lds
    buffer_load_dword v66, v59, s[12:15], s48 offen offset:2048 sc1
    buffer_load_dword v67, v59, s[12:15], s48 offen offset:3072 sc1
    v_mfma_f32_32x32x16_bf16 v[224:239], a[56:59], a[68:71], v[224:239]
    ds_read_b64_tr_b16 a[26:27], v28 offset:2048
    ds_read_b64_tr_b16 a[28:29], v29 offset:0
    s_add_u32 s48, s48, 4096
    buffer_load_dword v68, v59, s[12:15], s48 offen offset:0 sc1
    buffer_load_dword v69, v59, s[12:15], s48 offen offset:1024 sc1
    v_lshrrev_b32 v58, 7, v0
    v_mfma_f32_32x32x16_bf16 v[240:255], a[60:63], a[68:71], v[240:255]
    ds_read_b64_tr_b16 a[30:31], v29 offset:2048
    v_and_b32 v70, 127, v0
    v_mul_u32_u24 v58, s53, v58
    v_cmp_le_u32 vcc, s53, v70
    v_add_u32 v58, v58, v70
    s_waitcnt lgkmcnt(12)
    v_mfma_f32_32x32x16_bf16 v[128:143], a[0:3], a[64:67], v[128:143]
    s_add_u32 m0, s54, 2048
    ds_read_b128 a[68:71], v43
    ds_read_b64_tr_b16 a[32:33], v22 offset:8192
    ds_read_b64_tr_b16 a[34:35], v22 offset:10240
    buffer_load_dwordx4 v4, s[8:11], s45 offen lds
    v_lshlrev_b32 v58, 1, v58
    v_mov_b32 v70, 1073741824
    v_mfma_f32_32x32x16_bf16 v[144:159], a[4:7], a[64:67], v[144:159]
    ds_read_b64_tr_b16 a[36:37], v23 offset:8192
    ds_read_b64_tr_b16 a[38:39], v23 offset:10240
    ds_read_b64_tr_b16 a[40:41], v24 offset:8192
    v_cndmask_b32 v58, v58, v70, vcc
    s_mov_b32 s24, s66
    s_mov_b32 s25, s67
    s_cmp_eq_u32 s42, 1
    s_cselect_b32 s26, 0, 3456
    s_waitcnt lgkmcnt(14)
    v_mfma_f32_32x32x16_bf16 v[160:175], a[8:11], a[64:67], v[160:175]
    s_add_u32 m0, s54, 3072
    ds_read_b64_tr_b16 a[42:43], v24 offset:10240
    ds_read_b64_tr_b16 a[44:45], v25 offset:8192
    buffer_load_dwordx4 v5, s[8:11], s45 offen lds
    s_mov_b32 s27, 0x20000
    s_lshl_b32 s48, s40, 9
    buffer_load_ushort v58, v58, s[24:27], s48 offen
    v_mfma_f32_32x32x16_bf16 v[176:191], a[12:15], a[64:67], v[176:191]
    ds_read_b64_tr_b16 a[46:47], v25 offset:10240
    ds_read_b64_tr_b16 a[48:49], v26 offset:8192
    s_waitcnt lgkmcnt(14)
    v_mfma_f32_32x32x16_bf16 v[192:207], a[16:19], a[64:67], v[192:207]
    ds_read_b64_tr_b16 a[50:51], v26 offset:10240
    ds_read_b64_tr_b16 a[52:53], v27 offset:8192
    v_mfma_f32_32x32x16_bf16 v[208:223], a[20:23], a[64:67], v[208:223]
    s_add_u32 m0, s55, 33792
    ds_read_b64_tr_b16 a[54:55], v27 offset:10240
    ds_read_b64_tr_b16 a[56:57], v28 offset:8192
    buffer_load_dwordx4 v11, s[4:7], s46 offen lds
    s_waitcnt lgkmcnt(14)
    v_mfma_f32_32x32x16_bf16 v[224:239], a[24:27], a[64:67], v[224:239]
    ds_read_b64_tr_b16 a[58:59], v28 offset:10240
    ds_read_b64_tr_b16 a[60:61], v29 offset:8192
    v_mfma_f32_32x32x16_bf16 v[240:255], a[28:31], a[64:67], v[240:255]
    s_add_u32 m0, s54, 4096
    ds_read_b64_tr_b16 a[62:63], v29 offset:10240
    buffer_load_dwordx4 v6, s[8:11], s45 offen lds
    s_waitcnt lgkmcnt(12)
    v_mfma_f32_32x32x16_bf16 v[128:143], a[32:35], a[68:71], v[128:143]
    ds_read_b128 a[64:67], v44
    ds_read_b64_tr_b16 a[0:1], v22 offset:16384
    ds_read_b64_tr_b16 a[2:3], v22 offset:18432
    v_mfma_f32_32x32x16_bf16 v[144:159], a[36:39], a[68:71], v[144:159]
    ds_read_b64_tr_b16 a[4:5], v23 offset:16384
    ds_read_b64_tr_b16 a[6:7], v23 offset:18432
    ds_read_b64_tr_b16 a[8:9], v24 offset:16384
    s_waitcnt lgkmcnt(14)
    v_mfma_f32_32x32x16_bf16 v[160:175], a[40:43], a[68:71], v[160:175]
    s_add_u32 m0, s54, 5120
    ds_read_b64_tr_b16 a[10:11], v24 offset:18432
    ds_read_b64_tr_b16 a[12:13], v25 offset:16384
    buffer_load_dwordx4 v7, s[8:11], s45 offen lds
    v_mfma_f32_32x32x16_bf16 v[176:191], a[44:47], a[68:71], v[176:191]
    ds_read_b64_tr_b16 a[14:15], v25 offset:18432
    ds_read_b64_tr_b16 a[16:17], v26 offset:16384
    s_waitcnt lgkmcnt(14)
    v_mfma_f32_32x32x16_bf16 v[192:207], a[48:51], a[68:71], v[192:207]
    s_add_u32 m0, s55, 34816
    ds_read_b64_tr_b16 a[18:19], v26 offset:18432
    ds_read_b64_tr_b16 a[20:21], v27 offset:16384
    buffer_load_dwordx4 v12, s[4:7], s46 offen lds
    v_mfma_f32_32x32x16_bf16 v[208:223], a[52:55], a[68:71], v[208:223]
    ds_read_b64_tr_b16 a[22:23], v27 offset:18432
    ds_read_b64_tr_b16 a[24:25], v28 offset:16384
    s_waitcnt lgkmcnt(14)
    v_mfma_f32_32x32x16_bf16 v[224:239], a[56:59], a[68:71], v[224:239]
    ds_read_b64_tr_b16 a[26:27], v28 offset:18432
    ds_read_b64_tr_b16 a[28:29], v29 offset:16384
    v_mfma_f32_32x32x16_bf16 v[240:255], a[60:63], a[68:71], v[240:255]
    s_add_u32 m0, s54, 6144
    ds_read_b64_tr_b16 a[30:31], v29 offset:18432
    buffer_load_dwordx4 v8, s[8:11], s45 offen lds
    s_waitcnt lgkmcnt(12)
    v_mfma_f32_32x32x16_bf16 v[128:143], a[0:3], a[64:67], v[128:143]
    ds_read_b128 a[68:71], v45
    ds_read_b64_tr_b16 a[32:33], v22 offset:24576
    ds_read_b64_tr_b16 a[34:35], v22 offset:26624
    v_mfma_f32_32x32x16_bf16 v[144:159], a[4:7], a[64:67], v[144:159]
    s_add_u32 m0, s54, 7168
    ds_read_b64_tr_b16 a[36:37], v23 offset:24576
    ds_read_b64_tr_b16 a[38:39], v23 offset:26624
    ds_read_b64_tr_b16 a[40:41], v24 offset:24576
    buffer_load_dwordx4 v9, s[8:11], s45 offen lds
    s_waitcnt lgkmcnt(14)
    v_mfma_f32_32x32x16_bf16 v[160:175], a[8:11], a[64:67], v[160:175]
    ds_read_b64_tr_b16 a[42:43], v24 offset:26624
    ds_read_b64_tr_b16 a[44:45], v25 offset:24576
    v_mfma_f32_32x32x16_bf16 v[176:191], a[12:15], a[64:67], v[176:191]
    ds_read_b64_tr_b16 a[46:47], v25 offset:26624
    ds_read_b64_tr_b16 a[48:49], v26 offset:24576
    s_waitcnt lgkmcnt(14)
    v_mfma_f32_32x32x16_bf16 v[192:207], a[16:19], a[64:67], v[192:207]
    s_add_u32 m0, s55, 35840
    ds_read_b64_tr_b16 a[50:51], v26 offset:26624
    ds_read_b64_tr_b16 a[52:53], v27 offset:24576
    buffer_load_dwordx4 v13, s[4:7], s46 offen lds
    v_mfma_f32_32x32x16_bf16 v[208:223], a[20:23], a[64:67], v[208:223]
    ds_read_b64_tr_b16 a[54:55], v27 offset:26624
    ds_read_b64_tr_b16 a[56:57], v28 offset:24576
    s_waitcnt lgkmcnt(14)
    v_mfma_f32_32x32x16_bf16 v[224:239], a[24:27], a[64:67], v[224:239]
    ds_read_b64_tr_b16 a[58:59], v28 offset:26624
    ds_read_b64_tr_b16 a[60:61], v29 offset:24576
    v_mfma_f32_32x32x16_bf16 v[240:255], a[28:31], a[64:67], v[240:255]
    ds_read_b64_tr_b16 a[62:63], v29 offset:26624
    s_waitcnt lgkmcnt(0)
    s_waitcnt vmcnt(24)
    s_barrier
    v_mfma_f32_32x32x16_bf16 v[128:143], a[32:35], a[68:71], v[128:143]
    ds_read_b128 a[64:67], v46
    ds_read_b64_tr_b16 a[0:1], v30 offset:0
    ds_read_b64_tr_b16 a[2:3], v30 offset:2048
    s_add_u32 s65, s60, 0
    s_mul_i32 s65, s65, 5120
    buffer_load_dwordx4 a[112:115], v125, s[12:15], s65 offen offset:0 sc1
    v_mfma_f32_32x32x16_bf16 v[144:159], a[36:39], a[68:71], v[144:159]
    ds_read_b64_tr_b16 a[4:5], v31 offset:0
    ds_read_b64_tr_b16 a[6:7], v31 offset:2048
    ds_read_b64_tr_b16 a[8:9], v32 offset:0
    buffer_load_dwordx4 a[116:119], v125, s[12:15], s65 offen offset:1024 sc1
    v_mfma_f32_32x32x16_bf16 v[160:175], a[40:43], a[68:71], v[160:175]
    ds_read_b64_tr_b16 a[10:11], v32 offset:2048
    ds_read_b64_tr_b16 a[12:13], v33 offset:0
    v_mfma_f32_32x32x16_bf16 v[176:191], a[44:47], a[68:71], v[176:191]
    ds_read_b64_tr_b16 a[14:15], v33 offset:2048
    ds_read_b64_tr_b16 a[16:17], v34 offset:0
    buffer_load_dwordx4 a[120:123], v125, s[12:15], s65 offen offset:2048 sc1
    v_mfma_f32_32x32x16_bf16 v[192:207], a[48:51], a[68:71], v[192:207]
    ds_read_b64_tr_b16 a[18:19], v34 offset:2048
    ds_read_b64_tr_b16 a[20:21], v35 offset:0
    buffer_load_dwordx4 a[124:127], v125, s[12:15], s65 offen offset:3072 sc1
    s_waitcnt vmcnt(11)
    v_add_f32 v60, v60, v61
    v_mfma_f32_32x32x16_bf16 v[208:223], a[52:55], a[68:71], v[208:223]
    ds_read_b64_tr_b16 a[22:23], v35 offset:2048
    ds_read_b64_tr_b16 a[24:25], v36 offset:0
    v_add_f32 v60, v60, v62
    v_add_f32 v60, v60, v63
    buffer_load_dwordx4 a[128:131], v126, s[12:15], s65 offen offset:0 sc1
    v_add_f32 v60, v60, v64
    v_mfma_f32_32x32x16_bf16 v[224:239], a[56:59], a[68:71], v[224:239]
    ds_read_b64_tr_b16 a[26:27], v36 offset:2048
    ds_read_b64_tr_b16 a[28:29], v37 offset:0
    v_add_f32 v60, v60, v65
    v_add_f32 v60, v60, v66
    v_add_f32 v60, v60, v67
    s_add_u32 s65, s60, 1
    s_mul_i32 s65, s65, 5120
    buffer_load_dwordx4 a[132:135], v125, s[12:15], s65 offen offset:0 sc1
    v_mfma_f32_32x32x16_bf16 v[240:255], a[60:63], a[68:71], v[240:255]
    ds_read_b64_tr_b16 a[30:31], v37 offset:2048
    v_add_f32 v60, v60, v68
    v_add_f32 v60, v60, v69
    v_cvt_pk_bf16_f32 v61, v60, v60
    v_add_f32 v68, 0x3727c5ac, v57
    s_waitcnt lgkmcnt(12)
    v_mfma_f32_32x32x16_bf16 v[128:143], a[0:3], a[64:67], v[128:143]
    ds_read_b128 a[68:71], v47
    ds_read_b64_tr_b16 a[32:33], v30 offset:8192
    ds_read_b64_tr_b16 a[34:35], v30 offset:10240
    buffer_load_dwordx4 a[136:139], v125, s[12:15], s65 offen offset:1024 sc1
    v_and_b32 v61, 0xffff0000, v61
    v_rsq_f32 v74, v68
    v_sub_f32 v62, v60, v61
    v_mfma_f32_32x32x16_bf16 v[144:159], a[4:7], a[64:67], v[144:159]
    ds_read_b64_tr_b16 a[36:37], v31 offset:8192
    ds_read_b64_tr_b16 a[38:39], v31 offset:10240
    ds_read_b64_tr_b16 a[40:41], v32 offset:8192
    v_lshrrev_b32 v65, 16, v61
    buffer_load_dwordx4 a[140:143], v125, s[12:15], s65 offen offset:2048 sc1
    v_cvt_pk_bf16_f32 v64, v61, v62
    v_lshl_or_b32 v65, v58, 16, v65
    s_waitcnt lgkmcnt(14)
    v_mfma_f32_32x32x16_bf16 v[160:175], a[8:11], a[64:67], v[160:175]
    ds_read_b64_tr_b16 a[42:43], v32 offset:10240
    ds_read_b64_tr_b16 a[44:45], v33 offset:8192
    v_mov_b32 v66, v58
    v_mov_b32 v67, 0
    buffer_load_dwordx4 a[144:147], v125, s[12:15], s65 offen offset:3072 sc1
    v_lshlrev_b32 v59, 4, v0
    v_mfma_f32_32x32x16_bf16 v[176:191], a[12:15], a[64:67], v[176:191]
    ds_read_b64_tr_b16 a[46:47], v33 offset:10240
    ds_read_b64_tr_b16 a[48:49], v34 offset:8192
    v_add_u32 v59, 147456, v59
    ds_write_b128 v59, v[64:67]
    v_mul_f32 v60, v74, v74
    buffer_load_dwordx4 a[148:151], v126, s[12:15], s65 offen offset:0 sc1
    s_waitcnt lgkmcnt(15)
    v_mfma_f32_32x32x16_bf16 v[192:207], a[16:19], a[64:67], v[192:207]
    ds_read_b64_tr_b16 a[50:51], v34 offset:10240
    ds_read_b64_tr_b16 a[52:53], v35 offset:8192
    v_mov_b32 v61, 0x3727c5ac
    v_fmac_f32 v61, v57, v60
    s_cmp_eq_u32 s42, 1
    s_cselect_b64 vcc, -1, 0
    v_rsq_f32 v61, v61
    v_mfma_f32_32x32x16_bf16 v[208:223], a[20:23], a[64:67], v[208:223]
    ds_read_b64_tr_b16 a[54:55], v35 offset:10240
    ds_read_b64_tr_b16 a[56:57], v36 offset:8192
    v_bfe_u32 v68, v1, 2, 1
    s_add_u32 s65, s60, 2
    s_mul_i32 s65, s65, 5120
    buffer_load_dwordx4 a[152:155], v125, s[12:15], s65 offen offset:0 sc1
    s_waitcnt lgkmcnt(15)
    v_mfma_f32_32x32x16_bf16 v[224:239], a[24:27], a[64:67], v[224:239]
    ds_read_b64_tr_b16 a[58:59], v36 offset:10240
    ds_read_b64_tr_b16 a[60:61], v37 offset:8192
    v_cndmask_b32 v61, v61, 1.0, vcc
    v_mul_f32 v74, v74, v61
    v_bfe_u32 v69, v1, 4, 1
    v_rcp_f32 v75, v74
    v_mfma_f32_32x32x16_bf16 v[240:255], a[28:31], a[64:67], v[240:255]
    ds_read_b64_tr_b16 a[62:63], v37 offset:10240
    buffer_load_dwordx4 a[156:159], v125, s[12:15], s65 offen offset:1024 sc1
    v_and_b32 v76, 3, v1
    v_cvt_pk_bf16_f32 v60, v56, v75
    v_lshl_add_u32 v76, v68, 7, v76
    s_waitcnt lgkmcnt(13)
    v_mfma_f32_32x32x16_bf16 v[128:143], a[32:35], a[68:71], v[128:143]
    ds_read_b128 a[64:67], v48
    ds_read_b64_tr_b16 a[0:1], v30 offset:16384
    ds_read_b64_tr_b16 a[2:3], v30 offset:18432
    v_lshlrev_b32 v61, 16, v60
    buffer_load_dwordx4 a[160:163], v125, s[12:15], s65 offen offset:2048 sc1
    v_and_b32 v62, 0xffff0000, v60
    v_sub_f32 v63, v56, v61
    v_mfma_f32_32x32x16_bf16 v[144:159], a[36:39], a[68:71], v[144:159]
    ds_read_b64_tr_b16 a[4:5], v31 offset:16384
    ds_read_b64_tr_b16 a[6:7], v31 offset:18432
    ds_read_b64_tr_b16 a[8:9], v32 offset:16384
    v_sub_f32 v60, v75, v62
    v_cvt_pk_bf16_f32 v70, -v61, -v61
    buffer_load_dwordx4 a[164:167], v125, s[12:15], s65 offen offset:3072 sc1
    v_cvt_pk_bf16_f32 v71, -v63, v62
    s_waitcnt lgkmcnt(15)
    v_mfma_f32_32x32x16_bf16 v[160:175], a[40:43], a[68:71], v[160:175]
    ds_read_b64_tr_b16 a[10:11], v32 offset:18432
    ds_read_b64_tr_b16 a[12:13], v33 offset:16384
    v_cvt_pk_bf16_f32 v72, v60, 0
    v_cmp_gt_u32 vcc, 32, v1
    v_mov_b32 v73, 0
    buffer_load_dwordx4 a[168:171], v126, s[12:15], s65 offen offset:0 sc1
    v_mfma_f32_32x32x16_bf16 v[176:191], a[44:47], a[68:71], v[176:191]
    ds_read_b64_tr_b16 a[14:15], v33 offset:18432
    ds_read_b64_tr_b16 a[16:17], v34 offset:16384
    v_lshl_add_u32 v76, v69, 3, v76
    v_cndmask_b32 v70, 0, v70, vcc
    v_cndmask_b32 v71, 0, v71, vcc
    v_cndmask_b32 v72, 0, v72, vcc
    s_waitcnt lgkmcnt(14)
    v_mfma_f32_32x32x16_bf16 v[192:207], a[48:51], a[68:71], v[192:207]
    ds_read_b64_tr_b16 a[18:19], v34 offset:18432
    ds_read_b64_tr_b16 a[20:21], v35 offset:16384
    v_bfe_u32 v68, v1, 3, 1
    v_lshl_add_u32 v76, v68, 2, v76
    v_lshlrev_b32 v76, 4, v76
    v_add_u32 v76, 147456, v76
    v_mfma_f32_32x32x16_bf16 v[208:223], a[52:55], a[68:71], v[208:223]
    ds_read_b64_tr_b16 a[22:23], v35 offset:18432
    ds_read_b64_tr_b16 a[24:25], v36 offset:16384
    buffer_load_dwordx4 a[100:103], v116, s[4:7], 0 offen
    s_waitcnt lgkmcnt(14)
    v_mfma_f32_32x32x16_bf16 v[224:239], a[56:59], a[68:71], v[224:239]
    ds_read_b64_tr_b16 a[26:27], v36 offset:18432
    ds_read_b64_tr_b16 a[28:29], v37 offset:16384
    buffer_load_dwordx4 a[104:107], v117, s[4:7], 0 offen offset:1024
    v_mfma_f32_32x32x16_bf16 v[240:255], a[60:63], a[68:71], v[240:255]
    ds_read_b64_tr_b16 a[30:31], v37 offset:18432
    buffer_load_dwordx2 a[108:109], v115, s[4:7], 0 offen offset:2048
    s_waitcnt lgkmcnt(12)
    v_mfma_f32_32x32x16_bf16 v[128:143], a[0:3], a[64:67], v[128:143]
    ds_read_b128 a[68:71], v49
    ds_read_b64_tr_b16 a[32:33], v30 offset:24576
    ds_read_b64_tr_b16 a[34:35], v30 offset:26624
    buffer_load_dword a110, v118, s[32:35], 0 offen
    v_mfma_f32_32x32x16_bf16 v[144:159], a[4:7], a[64:67], v[144:159]
    ds_read_b64_tr_b16 a[36:37], v31 offset:24576
    ds_read_b64_tr_b16 a[38:39], v31 offset:26624
    ds_read_b64_tr_b16 a[40:41], v32 offset:24576
    s_waitcnt lgkmcnt(14)
    v_mfma_f32_32x32x16_bf16 v[160:175], a[8:11], a[64:67], v[160:175]
    ds_read_b64_tr_b16 a[42:43], v32 offset:26624
    ds_read_b64_tr_b16 a[44:45], v33 offset:24576
    v_mfma_f32_32x32x16_bf16 v[176:191], a[12:15], a[64:67], v[176:191]
    ds_read_b64_tr_b16 a[46:47], v33 offset:26624
    ds_read_b64_tr_b16 a[48:49], v34 offset:24576
    s_waitcnt lgkmcnt(14)
    v_mfma_f32_32x32x16_bf16 v[192:207], a[16:19], a[64:67], v[192:207]
    ds_read_b64_tr_b16 a[50:51], v34 offset:26624
    ds_read_b64_tr_b16 a[52:53], v35 offset:24576
    v_mfma_f32_32x32x16_bf16 v[208:223], a[20:23], a[64:67], v[208:223]
    ds_read_b64_tr_b16 a[54:55], v35 offset:26624
    ds_read_b64_tr_b16 a[56:57], v36 offset:24576
    s_waitcnt lgkmcnt(14)
    v_mfma_f32_32x32x16_bf16 v[224:239], a[24:27], a[64:67], v[224:239]
    ds_read_b64_tr_b16 a[58:59], v36 offset:26624
    ds_read_b64_tr_b16 a[60:61], v37 offset:24576
    v_mfma_f32_32x32x16_bf16 v[240:255], a[28:31], a[64:67], v[240:255]
    ds_read_b64_tr_b16 a[62:63], v37 offset:26624
    s_waitcnt lgkmcnt(0)
    s_waitcnt vmcnt(19)
    s_barrier
    v_mfma_f32_32x32x16_bf16 v[128:143], a[32:35], a[68:71], v[128:143]
    ds_read_b128 a[64:67], v38
    ds_read_b64_tr_b16 a[0:1], v14 offset:0
    ds_read_b64_tr_b16 a[2:3], v14 offset:2048
    s_add_u32 s65, s60, 3
    s_mul_i32 s65, s65, 5120
    buffer_load_dwordx4 a[172:175], v125, s[12:15], s65 offen offset:0 sc1
    v_mfma_f32_32x32x16_bf16 v[144:159], a[36:39], a[68:71], v[144:159]
    ds_read_b64_tr_b16 a[4:5], v15 offset:0
    ds_read_b64_tr_b16 a[6:7], v15 offset:2048
    ds_read_b64_tr_b16 a[8:9], v16 offset:0
    v_mfma_f32_32x32x16_bf16 v[160:175], a[40:43], a[68:71], v[160:175]
    ds_read_b64_tr_b16 a[10:11], v16 offset:2048
    ds_read_b64_tr_b16 a[12:13], v17 offset:0
    buffer_load_dwordx4 a[176:179], v125, s[12:15], s65 offen offset:1024 sc1
    v_mfma_f32_32x32x16_bf16 v[176:191], a[44:47], a[68:71], v[176:191]
    ds_read_b64_tr_b16 a[14:15], v17 offset:2048
    ds_read_b64_tr_b16 a[16:17], v18 offset:0
    buffer_load_dwordx4 a[180:183], v125, s[12:15], s65 offen offset:2048 sc1
    v_mfma_f32_32x32x16_bf16 v[192:207], a[48:51], a[68:71], v[192:207]
    ds_read_b64_tr_b16 a[18:19], v18 offset:2048
    ds_read_b64_tr_b16 a[20:21], v19 offset:0
    buffer_load_dwordx4 a[184:187], v125, s[12:15], s65 offen offset:3072 sc1
    v_mfma_f32_32x32x16_bf16 v[208:223], a[52:55], a[68:71], v[208:223]
    ds_read_b64_tr_b16 a[22:23], v19 offset:2048
    ds_read_b64_tr_b16 a[24:25], v20 offset:0
    v_mfma_f32_32x32x16_bf16 v[224:239], a[56:59], a[68:71], v[224:239]
    ds_read_b64_tr_b16 a[26:27], v20 offset:2048
    ds_read_b64_tr_b16 a[28:29], v21 offset:0
    buffer_load_dwordx4 a[188:191], v126, s[12:15], s65 offen offset:0 sc1
    v_mfma_f32_32x32x16_bf16 v[240:255], a[60:63], a[68:71], v[240:255]
    ds_read_b64_tr_b16 a[30:31], v21 offset:2048
    s_add_u32 s65, s60, 4
    s_mul_i32 s65, s65, 5120
    buffer_load_dwordx4 a[192:195], v125, s[12:15], s65 offen offset:0 sc1
    s_waitcnt lgkmcnt(12)
    v_mfma_f32_32x32x16_bf16 v[128:143], a[0:3], a[64:67], v[128:143]
    ds_read_b128 a[68:71], v39
    ds_read_b64_tr_b16 a[32:33], v14 offset:8192
    ds_read_b64_tr_b16 a[34:35], v14 offset:10240
    buffer_load_dwordx4 a[196:199], v125, s[12:15], s65 offen offset:1024 sc1
    v_mfma_f32_32x32x16_bf16 v[144:159], a[4:7], a[64:67], v[144:159]
    ds_read_b64_tr_b16 a[36:37], v15 offset:8192
    ds_read_b64_tr_b16 a[38:39], v15 offset:10240
    ds_read_b64_tr_b16 a[40:41], v16 offset:8192
    s_waitcnt lgkmcnt(14)
    v_mfma_f32_32x32x16_bf16 v[160:175], a[8:11], a[64:67], v[160:175]
    ds_read_b64_tr_b16 a[42:43], v16 offset:10240
    ds_read_b64_tr_b16 a[44:45], v17 offset:8192
    buffer_load_dwordx4 a[200:203], v125, s[12:15], s65 offen offset:2048 sc1
    v_mfma_f32_32x32x16_bf16 v[176:191], a[12:15], a[64:67], v[176:191]
    ds_read_b64_tr_b16 a[46:47], v17 offset:10240
    ds_read_b64_tr_b16 a[48:49], v18 offset:8192
    buffer_load_dwordx4 a[204:207], v125, s[12:15], s65 offen offset:3072 sc1
    s_waitcnt lgkmcnt(14)
    v_mfma_f32_32x32x16_bf16 v[192:207], a[16:19], a[64:67], v[192:207]
    ds_read_b64_tr_b16 a[50:51], v18 offset:10240
    ds_read_b64_tr_b16 a[52:53], v19 offset:8192
    buffer_load_dwordx4 a[208:211], v126, s[12:15], s65 offen offset:0 sc1
    v_mfma_f32_32x32x16_bf16 v[208:223], a[20:23], a[64:67], v[208:223]
    ds_read_b64_tr_b16 a[54:55], v19 offset:10240
    ds_read_b64_tr_b16 a[56:57], v20 offset:8192
    s_waitcnt lgkmcnt(14)
    v_mfma_f32_32x32x16_bf16 v[224:239], a[24:27], a[64:67], v[224:239]
    ds_read_b64_tr_b16 a[58:59], v20 offset:10240
    ds_read_b64_tr_b16 a[60:61], v21 offset:8192
    s_add_u32 s65, s63, 0
    s_mul_i32 s65, s65, 5120
    buffer_load_dwordx4 a[212:215], v125, s[12:15], s65 offen offset:0 sc1
    v_mfma_f32_32x32x16_bf16 v[240:255], a[28:31], a[64:67], v[240:255]
    ds_read_b64_tr_b16 a[62:63], v21 offset:10240
    buffer_load_dwordx4 a[216:219], v125, s[12:15], s65 offen offset:1024 sc1
    s_waitcnt lgkmcnt(12)
    v_mfma_f32_32x32x16_bf16 v[128:143], a[32:35], a[68:71], v[128:143]
    ds_read_b128 a[64:67], v40
    ds_read_b64_tr_b16 a[0:1], v14 offset:16384
    ds_read_b64_tr_b16 a[2:3], v14 offset:18432
    buffer_load_dwordx4 a[220:223], v125, s[12:15], s65 offen offset:2048 sc1
    v_mfma_f32_32x32x16_bf16 v[144:159], a[36:39], a[68:71], v[144:159]
    ds_read_b64_tr_b16 a[4:5], v15 offset:16384
    ds_read_b64_tr_b16 a[6:7], v15 offset:18432
    ds_read_b64_tr_b16 a[8:9], v16 offset:16384
    s_waitcnt lgkmcnt(14)
    v_mfma_f32_32x32x16_bf16 v[160:175], a[40:43], a[68:71], v[160:175]
    ds_read_b64_tr_b16 a[10:11], v16 offset:18432
    ds_read_b64_tr_b16 a[12:13], v17 offset:16384
    buffer_load_dwordx4 a[224:227], v125, s[12:15], s65 offen offset:3072 sc1
    v_mfma_f32_32x32x16_bf16 v[176:191], a[44:47], a[68:71], v[176:191]
    ds_read_b64_tr_b16 a[14:15], v17 offset:18432
    ds_read_b64_tr_b16 a[16:17], v18 offset:16384
    buffer_load_dwordx4 a[228:231], v126, s[12:15], s65 offen offset:0 sc1
    s_waitcnt lgkmcnt(14)
    v_mfma_f32_32x32x16_bf16 v[192:207], a[48:51], a[68:71], v[192:207]
    ds_read_b64_tr_b16 a[18:19], v18 offset:18432
    ds_read_b64_tr_b16 a[20:21], v19 offset:16384
    s_add_u32 s65, s63, 1
    s_mul_i32 s65, s65, 5120
    buffer_load_dwordx4 a[232:235], v125, s[12:15], s65 offen offset:0 sc1
    v_mfma_f32_32x32x16_bf16 v[208:223], a[52:55], a[68:71], v[208:223]
    ds_read_b64_tr_b16 a[22:23], v19 offset:18432
    ds_read_b64_tr_b16 a[24:25], v20 offset:16384
    s_waitcnt lgkmcnt(14)
    v_mfma_f32_32x32x16_bf16 v[224:239], a[56:59], a[68:71], v[224:239]
    ds_read_b64_tr_b16 a[26:27], v20 offset:18432
    ds_read_b64_tr_b16 a[28:29], v21 offset:16384
    buffer_load_dwordx4 a[236:239], v125, s[12:15], s65 offen offset:1024 sc1
    v_mfma_f32_32x32x16_bf16 v[240:255], a[60:63], a[68:71], v[240:255]
    ds_read_b64_tr_b16 a[30:31], v21 offset:18432
    buffer_load_dwordx4 a[240:243], v125, s[12:15], s65 offen offset:2048 sc1
    s_waitcnt lgkmcnt(12)
    v_mfma_f32_32x32x16_bf16 v[128:143], a[0:3], a[64:67], v[128:143]
    ds_read_b128 a[68:71], v41
    ds_read_b64_tr_b16 a[32:33], v14 offset:24576
    ds_read_b64_tr_b16 a[34:35], v14 offset:26624
    buffer_load_dwordx4 a[244:247], v125, s[12:15], s65 offen offset:3072 sc1
    v_mfma_f32_32x32x16_bf16 v[144:159], a[4:7], a[64:67], v[144:159]
    ds_read_b64_tr_b16 a[36:37], v15 offset:24576
    ds_read_b64_tr_b16 a[38:39], v15 offset:26624
    ds_read_b64_tr_b16 a[40:41], v16 offset:24576
    s_waitcnt lgkmcnt(14)
    v_mfma_f32_32x32x16_bf16 v[160:175], a[8:11], a[64:67], v[160:175]
    ds_read_b64_tr_b16 a[42:43], v16 offset:26624
    ds_read_b64_tr_b16 a[44:45], v17 offset:24576
    buffer_load_dwordx4 a[248:251], v126, s[12:15], s65 offen offset:0 sc1
    v_mfma_f32_32x32x16_bf16 v[176:191], a[12:15], a[64:67], v[176:191]
    ds_read_b64_tr_b16 a[46:47], v17 offset:26624
    ds_read_b64_tr_b16 a[48:49], v18 offset:24576
    s_waitcnt lgkmcnt(14)
    v_mfma_f32_32x32x16_bf16 v[192:207], a[16:19], a[64:67], v[192:207]
    ds_read_b64_tr_b16 a[50:51], v18 offset:26624
    ds_read_b64_tr_b16 a[52:53], v19 offset:24576
    v_mfma_f32_32x32x16_bf16 v[208:223], a[20:23], a[64:67], v[208:223]
    ds_read_b64_tr_b16 a[54:55], v19 offset:26624
    ds_read_b64_tr_b16 a[56:57], v20 offset:24576
    s_waitcnt lgkmcnt(14)
    v_mfma_f32_32x32x16_bf16 v[224:239], a[24:27], a[64:67], v[224:239]
    ds_read_b64_tr_b16 a[58:59], v20 offset:26624
    ds_read_b64_tr_b16 a[60:61], v21 offset:24576
    v_mfma_f32_32x32x16_bf16 v[240:255], a[28:31], a[64:67], v[240:255]
    ds_read_b64_tr_b16 a[62:63], v21 offset:26624
    s_waitcnt lgkmcnt(12)
    v_mfma_f32_32x32x16_bf16 v[128:143], a[32:35], a[68:71], v[128:143]
    ds_read_b128 a[0:3], v76 offset:0
    ds_read_b128 a[4:7], v76 offset:256
    ds_read_b128 a[8:11], v76 offset:512
    v_mfma_f32_32x32x16_bf16 v[144:159], a[36:39], a[68:71], v[144:159]
    ds_read_b128 a[12:15], v76 offset:768
    ds_read_b128 a[16:19], v76 offset:1024
    ds_read_b128 a[20:23], v76 offset:1280
    s_waitcnt lgkmcnt(14)
    v_mfma_f32_32x32x16_bf16 v[160:175], a[40:43], a[68:71], v[160:175]
    ds_read_b128 a[24:27], v76 offset:1536
    ds_read_b128 a[28:31], v76 offset:1792
    v_mfma_f32_32x32x16_bf16 v[176:191], a[44:47], a[68:71], v[176:191]
    s_waitcnt lgkmcnt(12)
    v_mfma_f32_32x32x16_bf16 v[192:207], a[48:51], a[68:71], v[192:207]
    v_mfma_f32_32x32x16_bf16 v[208:223], a[52:55], a[68:71], v[208:223]
    s_waitcnt lgkmcnt(8)
    v_mfma_f32_32x32x16_bf16 v[224:239], a[56:59], a[68:71], v[224:239]
    v_mfma_f32_32x32x16_bf16 v[240:255], a[60:63], a[68:71], v[240:255]
    s_waitcnt lgkmcnt(7)
    v_mfma_f32_32x32x16_bf16 v[128:143], a[0:3], v[70:73], v[128:143]
    s_waitcnt lgkmcnt(6)
    v_mfma_f32_32x32x16_bf16 v[144:159], a[4:7], v[70:73], v[144:159]
    s_waitcnt lgkmcnt(5)
    v_mfma_f32_32x32x16_bf16 v[160:175], a[8:11], v[70:73], v[160:175]
    s_waitcnt lgkmcnt(4)
    v_mfma_f32_32x32x16_bf16 v[176:191], a[12:15], v[70:73], v[176:191]
    s_waitcnt lgkmcnt(3)
    v_mfma_f32_32x32x16_bf16 v[192:207], a[16:19], v[70:73], v[192:207]
    s_waitcnt lgkmcnt(2)
    v_mfma_f32_32x32x16_bf16 v[208:223], a[20:23], v[70:73], v[208:223]
    s_waitcnt lgkmcnt(1)
    v_mfma_f32_32x32x16_bf16 v[224:239], a[24:27], v[70:73], v[224:239]
    s_waitcnt lgkmcnt(0)
    v_mfma_f32_32x32x16_bf16 v[240:255], a[28:31], v[70:73], v[240:255]
R_C:
CH_T:
    s_cbranch_execz Lwarm_ret0
    s_cmp_eq_u32 s42, 1
    s_cbranch_scc1 L1_attn
R_M:
CH_M0_0:
    s_cbranch_execz PD_M0_0_1
    v_mul_f32 v78, v74, v74
    v_mul_f32 v76, 0xc0135761, v74
    v_mul_f32 v78, v78, v74
    v_mul_f32 v78, 0xbdd2d3e8, v78
    v_mov_b32 v80, v75
    s_lshl_b32 s47, s36, 5
    s_add_u32 s47, s47, s41
    v_and_b32 v2, 31, v1
    v_add_u32 v2, s47, v2
    v_lshrrev_b32 v3, 4, v2
    v_mul_u32_u24 v3, 75776, v3
    v_and_b32 v2, 15, v2
    v_lshl_add_u32 v3, v2, 4, v3
PD_M0_0_1:
    s_cbranch_execz PD_M0_0_2
    v_lshrrev_b32 v2, 5, v1
    v_lshl_add_u32 v3, v2, 9, v3
    s_add_u32 s65, s63, 2
    s_mul_i32 s65, s65, 5120
    buffer_load_dwordx4 a[0:3], v125, s[12:15], s65 offen offset:0 sc1
    s_lshl_b32 s47, s40, 13
    s_add_u32 s47, s47, 20480
    s_add_u32 s48, s47, 4096
    v_pk_mul_f32 v[84:85], v[128:129], v[128:129]
    v_pk_mul_f32 v[86:87], v[130:131], v[130:131]
    v_pk_mul_f32 v[88:89], v[132:133], v[132:133]
    v_pk_mul_f32 v[90:91], v[134:135], v[134:135]
    v_pk_fma_f32 v[84:85], v[84:85], v[78:79], v[76:77] op_sel_hi:[1,0,0]
    v_pk_fma_f32 v[86:87], v[86:87], v[78:79], v[76:77] op_sel_hi:[1,0,0]
    v_pk_fma_f32 v[88:89], v[88:89], v[78:79], v[76:77] op_sel_hi:[1,0,0]
    v_pk_fma_f32 v[90:91], v[90:91], v[78:79], v[76:77] op_sel_hi:[1,0,0]
    v_pk_mul_f32 v[84:85], v[84:85], v[128:129]
PD_M0_0_2:
    s_cbranch_execz PD_M0_0_3
    v_pk_mul_f32 v[86:87], v[86:87], v[130:131]
    v_pk_mul_f32 v[88:89], v[88:89], v[132:133]
    v_pk_mul_f32 v[90:91], v[90:91], v[134:135]
    buffer_load_dwordx4 a[4:7], v125, s[12:15], s65 offen offset:1024 sc1
    v_exp_f32 v84, v84
    v_exp_f32 v85, v85
    v_exp_f32 v86, v86
    v_exp_f32 v87, v87
    v_exp_f32 v88, v88
    v_exp_f32 v89, v89
    v_exp_f32 v90, v90
    v_exp_f32 v91, v91
    v_pk_fma_f32 v[84:85], v[84:85], v[80:81], v[80:81] op_sel_hi:[1,0,0]
    v_pk_fma_f32 v[86:87], v[86:87], v[80:81], v[80:81] op_sel_hi:[1,0,0]
    v_pk_fma_f32 v[88:89], v[88:89], v[80:81], v[80:81] op_sel_hi:[1,0,0]
    v_pk_fma_f32 v[90:91], v[90:91], v[80:81], v[80:81] op_sel_hi:[1,0,0]
    v_rcp_f32 v84, v84
    v_rcp_f32 v85, v85
    v_rcp_f32 v86, v86
    buffer_load_dwordx4 a[8:11], v125, s[12:15], s65 offen offset:2048 sc1
    v_rcp_f32 v87, v87
PD_M0_0_3:
    s_cbranch_execz PD_M0_0_4
    v_rcp_f32 v88, v88
    v_rcp_f32 v89, v89
    v_rcp_f32 v90, v90
    v_rcp_f32 v91, v91
    v_pk_mul_f32 v[84:85], v[84:85], v[128:129]
    v_pk_mul_f32 v[86:87], v[86:87], v[130:131]
    v_pk_mul_f32 v[88:89], v[88:89], v[132:133]
    v_pk_mul_f32 v[90:91], v[90:91], v[134:135]
    v_cvt_pk_bf16_f32 v8, v84, v85
    v_cvt_pk_bf16_f32 v9, v86, v87
    v_cvt_pk_bf16_f32 v10, v88, v89
    v_cvt_pk_bf16_f32 v11, v90, v91
    buffer_store_dwordx4 v[8:11], v3, s[12:15], s47 offen offset:0 sc1
    v_pk_mul_f32 v[100:101], v[136:137], v[136:137]
    buffer_load_dwordx4 a[12:15], v125, s[12:15], s65 offen offset:3072 sc1
    v_pk_mul_f32 v[102:103], v[138:139], v[138:139]
    v_pk_mul_f32 v[104:105], v[140:141], v[140:141]
    v_pk_mul_f32 v[106:107], v[142:143], v[142:143]
PD_M0_0_4:
    s_cbranch_execz PD_M0_0_5
    v_pk_fma_f32 v[100:101], v[100:101], v[78:79], v[76:77] op_sel_hi:[1,0,0]
    v_pk_fma_f32 v[102:103], v[102:103], v[78:79], v[76:77] op_sel_hi:[1,0,0]
    v_pk_fma_f32 v[104:105], v[104:105], v[78:79], v[76:77] op_sel_hi:[1,0,0]
    v_pk_fma_f32 v[106:107], v[106:107], v[78:79], v[76:77] op_sel_hi:[1,0,0]
    v_pk_mul_f32 v[100:101], v[100:101], v[136:137]
    v_pk_mul_f32 v[102:103], v[102:103], v[138:139]
    v_pk_mul_f32 v[104:105], v[104:105], v[140:141]
    v_pk_mul_f32 v[106:107], v[106:107], v[142:143]
    v_exp_f32 v100, v100
    v_exp_f32 v101, v101
    v_exp_f32 v102, v102
    v_exp_f32 v103, v103
    buffer_load_dwordx4 a[16:19], v126, s[12:15], s65 offen offset:0 sc1
    v_exp_f32 v104, v104
    v_exp_f32 v105, v105
    v_exp_f32 v106, v106
    v_exp_f32 v107, v107
    v_pk_fma_f32 v[100:101], v[100:101], v[80:81], v[80:81] op_sel_hi:[1,0,0]
    v_pk_fma_f32 v[102:103], v[102:103], v[80:81], v[80:81] op_sel_hi:[1,0,0]
PD_M0_0_5:
    s_cbranch_execz PD_M0_0_6
    v_pk_fma_f32 v[104:105], v[104:105], v[80:81], v[80:81] op_sel_hi:[1,0,0]
    v_pk_fma_f32 v[106:107], v[106:107], v[80:81], v[80:81] op_sel_hi:[1,0,0]
    v_rcp_f32 v100, v100
    v_rcp_f32 v101, v101
    v_rcp_f32 v102, v102
    v_rcp_f32 v103, v103
    v_rcp_f32 v104, v104
    v_rcp_f32 v105, v105
    v_rcp_f32 v106, v106
    s_add_u32 s65, s63, 3
    s_mul_i32 s65, s65, 5120
    buffer_load_dwordx4 a[20:23], v125, s[12:15], s65 offen offset:0 sc1
    v_rcp_f32 v107, v107
    v_pk_mul_f32 v[100:101], v[100:101], v[136:137]
    v_pk_mul_f32 v[102:103], v[102:103], v[138:139]
    v_pk_mul_f32 v[104:105], v[104:105], v[140:141]
    v_pk_mul_f32 v[106:107], v[106:107], v[142:143]
    v_cvt_pk_bf16_f32 v12, v100, v101
    v_cvt_pk_bf16_f32 v13, v102, v103
    v_cvt_pk_bf16_f32 v14, v104, v105
PD_M0_0_6:
    s_cbranch_execz PD_M0_0_7
    v_cvt_pk_bf16_f32 v15, v106, v107
    buffer_store_dwordx4 v[12:15], v3, s[12:15], s47 offen offset:256 sc1
    v_pk_mul_f32 v[84:85], v[144:145], v[144:145]
    v_pk_mul_f32 v[86:87], v[146:147], v[146:147]
    v_pk_mul_f32 v[88:89], v[148:149], v[148:149]
    v_pk_mul_f32 v[90:91], v[150:151], v[150:151]
    v_pk_fma_f32 v[84:85], v[84:85], v[78:79], v[76:77] op_sel_hi:[1,0,0]
    buffer_load_dwordx4 a[24:27], v125, s[12:15], s65 offen offset:1024 sc1
    v_pk_fma_f32 v[86:87], v[86:87], v[78:79], v[76:77] op_sel_hi:[1,0,0]
    v_pk_fma_f32 v[88:89], v[88:89], v[78:79], v[76:77] op_sel_hi:[1,0,0]
    v_pk_fma_f32 v[90:91], v[90:91], v[78:79], v[76:77] op_sel_hi:[1,0,0]
    v_pk_mul_f32 v[84:85], v[84:85], v[144:145]
    v_pk_mul_f32 v[86:87], v[86:87], v[146:147]
    v_pk_mul_f32 v[88:89], v[88:89], v[148:149]
    v_pk_mul_f32 v[90:91], v[90:91], v[150:151]
    v_exp_f32 v84, v84
PD_M0_0_7:
    s_cbranch_execz PD_M0_0_8
    v_exp_f32 v85, v85
    v_exp_f32 v86, v86
    v_exp_f32 v87, v87
    v_exp_f32 v88, v88
    v_exp_f32 v89, v89
    v_exp_f32 v90, v90
    v_exp_f32 v91, v91
    buffer_load_dwordx4 a[28:31], v125, s[12:15], s65 offen offset:2048 sc1
    v_pk_fma_f32 v[84:85], v[84:85], v[80:81], v[80:81] op_sel_hi:[1,0,0]
    v_pk_fma_f32 v[86:87], v[86:87], v[80:81], v[80:81] op_sel_hi:[1,0,0]
    v_pk_fma_f32 v[88:89], v[88:89], v[80:81], v[80:81] op_sel_hi:[1,0,0]
    v_pk_fma_f32 v[90:91], v[90:91], v[80:81], v[80:81] op_sel_hi:[1,0,0]
    v_rcp_f32 v84, v84
    v_rcp_f32 v85, v85
    v_rcp_f32 v86, v86
    v_rcp_f32 v87, v87
    v_rcp_f32 v88, v88
    v_rcp_f32 v89, v89
    v_rcp_f32 v90, v90
    v_rcp_f32 v91, v91
    v_pk_mul_f32 v[84:85], v[84:85], v[144:145]
    v_pk_mul_f32 v[86:87], v[86:87], v[146:147]
    v_pk_mul_f32 v[88:89], v[88:89], v[148:149]
PD_M0_0_8:
    s_cbranch_execz Lwarm_ret0
    buffer_load_dwordx4 a[32:35], v125, s[12:15], s65 offen offset:3072 sc1
    v_pk_mul_f32 v[90:91], v[90:91], v[150:151]
    v_cvt_pk_bf16_f32 v16, v84, v85
    v_cvt_pk_bf16_f32 v17, v86, v87
    v_cvt_pk_bf16_f32 v18, v88, v89
    v_cvt_pk_bf16_f32 v19, v90, v91
    buffer_store_dwordx4 v[16:19], v3, s[12:15], s47 offen offset:1024 sc1
    v_pk_mul_f32 v[100:101], v[152:153], v[152:153]
    v_pk_mul_f32 v[102:103], v[154:155], v[154:155]
    v_pk_mul_f32 v[104:105], v[156:157], v[156:157]
    v_pk_mul_f32 v[106:107], v[158:159], v[158:159]
    v_pk_fma_f32 v[100:101], v[100:101], v[78:79], v[76:77] op_sel_hi:[1,0,0]
    v_pk_fma_f32 v[102:103], v[102:103], v[78:79], v[76:77] op_sel_hi:[1,0,0]
    v_pk_fma_f32 v[104:105], v[104:105], v[78:79], v[76:77] op_sel_hi:[1,0,0]
    v_pk_fma_f32 v[106:107], v[106:107], v[78:79], v[76:77] op_sel_hi:[1,0,0]
    v_pk_mul_f32 v[100:101], v[100:101], v[152:153]
CH_M1_0:
    s_cbranch_execz PD_M1_0_1
    buffer_load_dwordx4 a[36:39], v126, s[12:15], s65 offen offset:0 sc1
    v_pk_mul_f32 v[102:103], v[102:103], v[154:155]
    v_pk_mul_f32 v[104:105], v[104:105], v[156:157]
    v_pk_mul_f32 v[106:107], v[106:107], v[158:159]
    v_exp_f32 v100, v100
    v_exp_f32 v101, v101
    v_exp_f32 v102, v102
    v_exp_f32 v103, v103
    v_exp_f32 v104, v104
    v_exp_f32 v105, v105
    v_exp_f32 v106, v106
    v_exp_f32 v107, v107
    v_pk_fma_f32 v[100:101], v[100:101], v[80:81], v[80:81] op_sel_hi:[1,0,0]
    v_pk_fma_f32 v[102:103], v[102:103], v[80:81], v[80:81] op_sel_hi:[1,0,0]
    v_pk_fma_f32 v[104:105], v[104:105], v[80:81], v[80:81] op_sel_hi:[1,0,0]
    v_pk_fma_f32 v[106:107], v[106:107], v[80:81], v[80:81] op_sel_hi:[1,0,0]
    s_add_u32 s65, s63, 4
    s_mul_i32 s65, s65, 5120
    buffer_load_dwordx4 a[40:43], v125, s[12:15], s65 offen offset:0 sc1
    v_rcp_f32 v100, v100
PD_M1_0_1:
    s_cbranch_execz PD_M1_0_2
    v_rcp_f32 v101, v101
    v_rcp_f32 v102, v102
    v_rcp_f32 v103, v103
    v_rcp_f32 v104, v104
    v_rcp_f32 v105, v105
    v_rcp_f32 v106, v106
    v_rcp_f32 v107, v107
    v_pk_mul_f32 v[100:101], v[100:101], v[152:153]
    v_pk_mul_f32 v[102:103], v[102:103], v[154:155]
    v_pk_mul_f32 v[104:105], v[104:105], v[156:157]
    v_pk_mul_f32 v[106:107], v[106:107], v[158:159]
    v_cvt_pk_bf16_f32 v20, v100, v101
    v_cvt_pk_bf16_f32 v21, v102, v103
    v_cvt_pk_bf16_f32 v22, v104, v105
    buffer_load_dwordx4 a[44:47], v125, s[12:15], s65 offen offset:1024 sc1
    v_cvt_pk_bf16_f32 v23, v106, v107
    buffer_store_dwordx4 v[20:23], v3, s[12:15], s47 offen offset:1280 sc1
    v_pk_mul_f32 v[84:85], v[160:161], v[160:161]
    v_pk_mul_f32 v[86:87], v[162:163], v[162:163]
PD_M1_0_2:
    s_cbranch_execz PD_M1_0_3
    v_pk_mul_f32 v[88:89], v[164:165], v[164:165]
    v_pk_mul_f32 v[90:91], v[166:167], v[166:167]
    v_pk_fma_f32 v[84:85], v[84:85], v[78:79], v[76:77] op_sel_hi:[1,0,0]
    v_pk_fma_f32 v[86:87], v[86:87], v[78:79], v[76:77] op_sel_hi:[1,0,0]
    v_pk_fma_f32 v[88:89], v[88:89], v[78:79], v[76:77] op_sel_hi:[1,0,0]
    v_pk_fma_f32 v[90:91], v[90:91], v[78:79], v[76:77] op_sel_hi:[1,0,0]
    v_pk_mul_f32 v[84:85], v[84:85], v[160:161]
    v_pk_mul_f32 v[86:87], v[86:87], v[162:163]
    v_pk_mul_f32 v[88:89], v[88:89], v[164:165]
    v_pk_mul_f32 v[90:91], v[90:91], v[166:167]
    v_exp_f32 v84, v84
    buffer_load_dwordx4 a[48:51], v125, s[12:15], s65 offen offset:2048 sc1
    v_exp_f32 v85, v85
    v_exp_f32 v86, v86
    v_exp_f32 v87, v87
    v_exp_f32 v88, v88
    v_exp_f32 v89, v89
    v_exp_f32 v90, v90
    v_exp_f32 v91, v91
    v_pk_fma_f32 v[84:85], v[84:85], v[80:81], v[80:81] op_sel_hi:[1,0,0]
PD_M1_0_3:
    s_cbranch_execz PD_M1_0_4
    v_pk_fma_f32 v[86:87], v[86:87], v[80:81], v[80:81] op_sel_hi:[1,0,0]
    v_pk_fma_f32 v[88:89], v[88:89], v[80:81], v[80:81] op_sel_hi:[1,0,0]
    v_pk_fma_f32 v[90:91], v[90:91], v[80:81], v[80:81] op_sel_hi:[1,0,0]
    v_rcp_f32 v84, v84
    v_rcp_f32 v85, v85
    v_rcp_f32 v86, v86
    v_rcp_f32 v87, v87
    buffer_load_dwordx4 a[52:55], v125, s[12:15], s65 offen offset:3072 sc1
    v_rcp_f32 v88, v88
    v_rcp_f32 v89, v89
    v_rcp_f32 v90, v90
    v_rcp_f32 v91, v91
    v_pk_mul_f32 v[84:85], v[84:85], v[160:161]
    v_pk_mul_f32 v[86:87], v[86:87], v[162:163]
    v_pk_mul_f32 v[88:89], v[88:89], v[164:165]
    v_pk_mul_f32 v[90:91], v[90:91], v[166:167]
    v_cvt_pk_bf16_f32 v8, v84, v85
    v_cvt_pk_bf16_f32 v9, v86, v87
    v_cvt_pk_bf16_f32 v10, v88, v89
PD_M1_0_4:
    s_cbranch_execz PD_M1_0_5
    v_cvt_pk_bf16_f32 v11, v90, v91
    buffer_store_dwordx4 v[8:11], v3, s[12:15], s47 offen offset:2048 sc1
    v_pk_mul_f32 v[100:101], v[168:169], v[168:169]
    v_pk_mul_f32 v[102:103], v[170:171], v[170:171]
    buffer_load_dwordx4 a[56:59], v126, s[12:15], s65 offen offset:0 sc1
    v_pk_mul_f32 v[104:105], v[172:173], v[172:173]
    v_pk_mul_f32 v[106:107], v[174:175], v[174:175]
    v_pk_fma_f32 v[100:101], v[100:101], v[78:79], v[76:77] op_sel_hi:[1,0,0]
    v_pk_fma_f32 v[102:103], v[102:103], v[78:79], v[76:77] op_sel_hi:[1,0,0]
    v_pk_fma_f32 v[104:105], v[104:105], v[78:79], v[76:77] op_sel_hi:[1,0,0]
    v_pk_fma_f32 v[106:107], v[106:107], v[78:79], v[76:77] op_sel_hi:[1,0,0]
    v_pk_mul_f32 v[100:101], v[100:101], v[168:169]
    v_pk_mul_f32 v[102:103], v[102:103], v[170:171]
    v_pk_mul_f32 v[104:105], v[104:105], v[172:173]
    v_pk_mul_f32 v[106:107], v[106:107], v[174:175]
    v_exp_f32 v100, v100
PD_M1_0_5:
    s_cbranch_execz PD_M1_0_6
    v_exp_f32 v101, v101
    v_exp_f32 v102, v102
    v_exp_f32 v103, v103
    v_exp_f32 v104, v104
    s_add_u32 s65, s63, 5
    s_mul_i32 s65, s65, 5120
    buffer_load_dwordx4 a[60:63], v125, s[12:15], s65 offen offset:0 sc1
    v_exp_f32 v105, v105
    v_exp_f32 v106, v106
    v_exp_f32 v107, v107
    v_pk_fma_f32 v[100:101], v[100:101], v[80:81], v[80:81] op_sel_hi:[1,0,0]
    v_pk_fma_f32 v[102:103], v[102:103], v[80:81], v[80:81] op_sel_hi:[1,0,0]
    v_pk_fma_f32 v[104:105], v[104:105], v[80:81], v[80:81] op_sel_hi:[1,0,0]
    v_pk_fma_f32 v[106:107], v[106:107], v[80:81], v[80:81] op_sel_hi:[1,0,0]
    v_rcp_f32 v100, v100
    v_rcp_f32 v101, v101
    v_rcp_f32 v102, v102
    v_rcp_f32 v103, v103
    v_rcp_f32 v104, v104
    v_rcp_f32 v105, v105
    v_rcp_f32 v106, v106
    v_rcp_f32 v107, v107
    buffer_load_dwordx4 a[64:67], v125, s[12:15], s65 offen offset:1024 sc1
    v_pk_mul_f32 v[100:101], v[100:101], v[168:169]
PD_M1_0_6:
    s_cbranch_execz PD_M1_0_7
    v_pk_mul_f32 v[102:103], v[102:103], v[170:171]
    v_pk_mul_f32 v[104:105], v[104:105], v[172:173]
    v_pk_mul_f32 v[106:107], v[106:107], v[174:175]
    v_cvt_pk_bf16_f32 v12, v100, v101
    v_cvt_pk_bf16_f32 v13, v102, v103
    v_cvt_pk_bf16_f32 v14, v104, v105
    v_cvt_pk_bf16_f32 v15, v106, v107
    buffer_store_dwordx4 v[12:15], v3, s[12:15], s47 offen offset:2304 sc1
    v_pk_mul_f32 v[84:85], v[176:177], v[176:177]
    v_pk_mul_f32 v[86:87], v[178:179], v[178:179]
    v_pk_mul_f32 v[88:89], v[180:181], v[180:181]
    v_pk_mul_f32 v[90:91], v[182:183], v[182:183]
    v_pk_fma_f32 v[84:85], v[84:85], v[78:79], v[76:77] op_sel_hi:[1,0,0]
    v_pk_fma_f32 v[86:87], v[86:87], v[78:79], v[76:77] op_sel_hi:[1,0,0]
    buffer_load_dwordx4 a[68:71], v125, s[12:15], s65 offen offset:2048 sc1
PD_M1_0_7:
    s_cbranch_execz PD_M1_0_8
    v_pk_fma_f32 v[88:89], v[88:89], v[78:79], v[76:77] op_sel_hi:[1,0,0]
    v_pk_fma_f32 v[90:91], v[90:91], v[78:79], v[76:77] op_sel_hi:[1,0,0]
    v_pk_mul_f32 v[84:85], v[84:85], v[176:177]
    v_pk_mul_f32 v[86:87], v[86:87], v[178:179]
    v_pk_mul_f32 v[88:89], v[88:89], v[180:181]
    v_pk_mul_f32 v[90:91], v[90:91], v[182:183]
    v_exp_f32 v84, v84
    v_exp_f32 v85, v85
    v_exp_f32 v86, v86
    v_exp_f32 v87, v87
    v_exp_f32 v88, v88
    v_exp_f32 v89, v89
    v_exp_f32 v90, v90
    v_exp_f32 v91, v91
    v_pk_fma_f32 v[84:85], v[84:85], v[80:81], v[80:81] op_sel_hi:[1,0,0]
    buffer_load_dwordx4 a[72:75], v125, s[12:15], s65 offen offset:3072 sc1
    v_pk_fma_f32 v[86:87], v[86:87], v[80:81], v[80:81] op_sel_hi:[1,0,0]
    v_pk_fma_f32 v[88:89], v[88:89], v[80:81], v[80:81] op_sel_hi:[1,0,0]
    v_pk_fma_f32 v[90:91], v[90:91], v[80:81], v[80:81] op_sel_hi:[1,0,0]
    v_rcp_f32 v84, v84
PD_M1_0_8:
    s_cbranch_execz PD_M1_0_9
    v_rcp_f32 v85, v85
    v_rcp_f32 v86, v86
    v_rcp_f32 v87, v87
    v_rcp_f32 v88, v88
    v_rcp_f32 v89, v89
    v_rcp_f32 v90, v90
    v_rcp_f32 v91, v91
    v_pk_mul_f32 v[84:85], v[84:85], v[176:177]
    v_pk_mul_f32 v[86:87], v[86:87], v[178:179]
    v_pk_mul_f32 v[88:89], v[88:89], v[180:181]
    v_pk_mul_f32 v[90:91], v[90:91], v[182:183]
    buffer_load_dwordx4 a[76:79], v126, s[12:15], s65 offen offset:0 sc1
    v_cvt_pk_bf16_f32 v16, v84, v85
    v_cvt_pk_bf16_f32 v17, v86, v87
    v_cvt_pk_bf16_f32 v18, v88, v89
    v_cvt_pk_bf16_f32 v19, v90, v91
    buffer_store_dwordx4 v[16:19], v3, s[12:15], s47 offen offset:3072 sc1
    v_pk_mul_f32 v[100:101], v[184:185], v[184:185]
    v_pk_mul_f32 v[102:103], v[186:187], v[186:187]
PD_M1_0_9:
    s_cbranch_execz Lwarm_ret0
    v_pk_mul_f32 v[104:105], v[188:189], v[188:189]
    v_pk_mul_f32 v[106:107], v[190:191], v[190:191]
    v_pk_fma_f32 v[100:101], v[100:101], v[78:79], v[76:77] op_sel_hi:[1,0,0]
    v_pk_fma_f32 v[102:103], v[102:103], v[78:79], v[76:77] op_sel_hi:[1,0,0]
    v_pk_fma_f32 v[104:105], v[104:105], v[78:79], v[76:77] op_sel_hi:[1,0,0]
    v_pk_fma_f32 v[106:107], v[106:107], v[78:79], v[76:77] op_sel_hi:[1,0,0]
    v_pk_mul_f32 v[100:101], v[100:101], v[184:185]
    v_pk_mul_f32 v[102:103], v[102:103], v[186:187]
    s_add_u32 s65, s63, 6
    s_mul_i32 s65, s65, 5120
    buffer_load_dwordx4 a[80:83], v125, s[12:15], s65 offen offset:0 sc1
    v_pk_mul_f32 v[104:105], v[104:105], v[188:189]
    v_pk_mul_f32 v[106:107], v[106:107], v[190:191]
    v_exp_f32 v100, v100
    v_exp_f32 v101, v101
    v_exp_f32 v102, v102
    v_exp_f32 v103, v103
    v_exp_f32 v104, v104
    v_exp_f32 v105, v105
CH_M2_0:
    s_cbranch_execz PD_M2_0_1
    v_exp_f32 v106, v106
    v_exp_f32 v107, v107
    v_pk_fma_f32 v[100:101], v[100:101], v[80:81], v[80:81] op_sel_hi:[1,0,0]
    v_pk_fma_f32 v[102:103], v[102:103], v[80:81], v[80:81] op_sel_hi:[1,0,0]
    v_pk_fma_f32 v[104:105], v[104:105], v[80:81], v[80:81] op_sel_hi:[1,0,0]
    v_pk_fma_f32 v[106:107], v[106:107], v[80:81], v[80:81] op_sel_hi:[1,0,0]
    v_rcp_f32 v100, v100
    buffer_load_dwordx4 a[84:87], v125, s[12:15], s65 offen offset:1024 sc1
    v_rcp_f32 v101, v101
    v_rcp_f32 v102, v102
    v_rcp_f32 v103, v103
    v_rcp_f32 v104, v104
    v_rcp_f32 v105, v105
    v_rcp_f32 v106, v106
    v_rcp_f32 v107, v107
    v_pk_mul_f32 v[100:101], v[100:101], v[184:185]
    v_pk_mul_f32 v[102:103], v[102:103], v[186:187]
    v_pk_mul_f32 v[104:105], v[104:105], v[188:189]
    v_pk_mul_f32 v[106:107], v[106:107], v[190:191]
    v_cvt_pk_bf16_f32 v20, v100, v101
    v_cvt_pk_bf16_f32 v21, v102, v103
PD_M2_0_1:
    s_cbranch_execz PD_M2_0_2
    v_cvt_pk_bf16_f32 v22, v104, v105
    v_cvt_pk_bf16_f32 v23, v106, v107
    buffer_load_dwordx4 a[88:91], v125, s[12:15], s65 offen offset:2048 sc1
    buffer_store_dwordx4 v[20:23], v3, s[12:15], s47 offen offset:3328 sc1
    v_pk_mul_f32 v[84:85], v[192:193], v[192:193]
    v_pk_mul_f32 v[86:87], v[194:195], v[194:195]
    v_pk_mul_f32 v[88:89], v[196:197], v[196:197]
    v_pk_mul_f32 v[90:91], v[198:199], v[198:199]
    v_pk_fma_f32 v[84:85], v[84:85], v[78:79], v[76:77] op_sel_hi:[1,0,0]
    v_pk_fma_f32 v[86:87], v[86:87], v[78:79], v[76:77] op_sel_hi:[1,0,0]
    v_pk_fma_f32 v[88:89], v[88:89], v[78:79], v[76:77] op_sel_hi:[1,0,0]
    v_pk_fma_f32 v[90:91], v[90:91], v[78:79], v[76:77] op_sel_hi:[1,0,0]
    v_pk_mul_f32 v[84:85], v[84:85], v[192:193]
    v_pk_mul_f32 v[86:87], v[86:87], v[194:195]
    v_pk_mul_f32 v[88:89], v[88:89], v[196:197]
PD_M2_0_2:
    s_cbranch_execz PD_M2_0_3
    v_pk_mul_f32 v[90:91], v[90:91], v[198:199]
    v_exp_f32 v84, v84
    v_exp_f32 v85, v85
    buffer_load_dwordx4 a[92:95], v125, s[12:15], s65 offen offset:3072 sc1
    v_exp_f32 v86, v86
    v_exp_f32 v87, v87
    v_exp_f32 v88, v88
    v_exp_f32 v89, v89
    v_exp_f32 v90, v90
    v_exp_f32 v91, v91
    v_pk_fma_f32 v[84:85], v[84:85], v[80:81], v[80:81] op_sel_hi:[1,0,0]
    v_pk_fma_f32 v[86:87], v[86:87], v[80:81], v[80:81] op_sel_hi:[1,0,0]
    v_pk_fma_f32 v[88:89], v[88:89], v[80:81], v[80:81] op_sel_hi:[1,0,0]
    v_pk_fma_f32 v[90:91], v[90:91], v[80:81], v[80:81] op_sel_hi:[1,0,0]
    v_rcp_f32 v84, v84
    v_rcp_f32 v85, v85
    v_rcp_f32 v86, v86
    v_rcp_f32 v87, v87
    v_rcp_f32 v88, v88
    buffer_load_dwordx4 a[96:99], v126, s[12:15], s65 offen offset:0 sc1
    v_rcp_f32 v89, v89
    v_rcp_f32 v90, v90
    v_rcp_f32 v91, v91
    v_pk_mul_f32 v[84:85], v[84:85], v[192:193]
PD_M2_0_3:
    s_cbranch_execz PD_M2_0_4
    v_pk_mul_f32 v[86:87], v[86:87], v[194:195]
    v_pk_mul_f32 v[88:89], v[88:89], v[196:197]
    v_pk_mul_f32 v[90:91], v[90:91], v[198:199]
    v_cvt_pk_bf16_f32 v8, v84, v85
    v_cvt_pk_bf16_f32 v9, v86, v87
    v_cvt_pk_bf16_f32 v10, v88, v89
    v_cvt_pk_bf16_f32 v11, v90, v91
    buffer_store_dwordx4 v[8:11], v3, s[12:15], s48 offen offset:0 sc1
    v_pk_mul_f32 v[100:101], v[200:201], v[200:201]
    v_pk_mul_f32 v[102:103], v[202:203], v[202:203]
    v_pk_mul_f32 v[104:105], v[204:205], v[204:205]
    v_pk_mul_f32 v[106:107], v[206:207], v[206:207]
    v_pk_fma_f32 v[100:101], v[100:101], v[78:79], v[76:77] op_sel_hi:[1,0,0]
    v_pk_fma_f32 v[102:103], v[102:103], v[78:79], v[76:77] op_sel_hi:[1,0,0]
    v_pk_fma_f32 v[104:105], v[104:105], v[78:79], v[76:77] op_sel_hi:[1,0,0]
PD_M2_0_4:
    s_cbranch_execz PD_M2_0_5
    v_pk_fma_f32 v[106:107], v[106:107], v[78:79], v[76:77] op_sel_hi:[1,0,0]
    v_pk_mul_f32 v[100:101], v[100:101], v[200:201]
    v_pk_mul_f32 v[102:103], v[102:103], v[202:203]
    v_pk_mul_f32 v[104:105], v[104:105], v[204:205]
    v_pk_mul_f32 v[106:107], v[106:107], v[206:207]
    v_exp_f32 v100, v100
    v_exp_f32 v101, v101
    v_exp_f32 v102, v102
    v_exp_f32 v103, v103
    v_exp_f32 v104, v104
    v_exp_f32 v105, v105
    v_exp_f32 v106, v106
    v_exp_f32 v107, v107
    v_pk_fma_f32 v[100:101], v[100:101], v[80:81], v[80:81] op_sel_hi:[1,0,0]
    v_pk_fma_f32 v[102:103], v[102:103], v[80:81], v[80:81] op_sel_hi:[1,0,0]
    v_pk_fma_f32 v[104:105], v[104:105], v[80:81], v[80:81] op_sel_hi:[1,0,0]
    v_pk_fma_f32 v[106:107], v[106:107], v[80:81], v[80:81] op_sel_hi:[1,0,0]
    v_rcp_f32 v100, v100
    v_rcp_f32 v101, v101
    v_rcp_f32 v102, v102
    v_rcp_f32 v103, v103
    v_rcp_f32 v104, v104
PD_M2_0_5:
    s_cbranch_execz PD_M2_0_6
    v_rcp_f32 v105, v105
    v_rcp_f32 v106, v106
    v_rcp_f32 v107, v107
    v_pk_mul_f32 v[100:101], v[100:101], v[200:201]
    v_pk_mul_f32 v[102:103], v[102:103], v[202:203]
    v_pk_mul_f32 v[104:105], v[104:105], v[204:205]
    v_pk_mul_f32 v[106:107], v[106:107], v[206:207]
    v_cvt_pk_bf16_f32 v12, v100, v101
    v_cvt_pk_bf16_f32 v13, v102, v103
    v_cvt_pk_bf16_f32 v14, v104, v105
    v_cvt_pk_bf16_f32 v15, v106, v107
    buffer_store_dwordx4 v[12:15], v3, s[12:15], s48 offen offset:256 sc1
    v_pk_mul_f32 v[84:85], v[208:209], v[208:209]
    v_pk_mul_f32 v[86:87], v[210:211], v[210:211]
    v_pk_mul_f32 v[88:89], v[212:213], v[212:213]
    v_pk_mul_f32 v[90:91], v[214:215], v[214:215]
    v_pk_fma_f32 v[84:85], v[84:85], v[78:79], v[76:77] op_sel_hi:[1,0,0]
PD_M2_0_6:
    s_cbranch_execz PD_M2_0_7
    v_pk_fma_f32 v[86:87], v[86:87], v[78:79], v[76:77] op_sel_hi:[1,0,0]
    v_pk_fma_f32 v[88:89], v[88:89], v[78:79], v[76:77] op_sel_hi:[1,0,0]
    v_pk_fma_f32 v[90:91], v[90:91], v[78:79], v[76:77] op_sel_hi:[1,0,0]
    v_pk_mul_f32 v[84:85], v[84:85], v[208:209]
    v_pk_mul_f32 v[86:87], v[86:87], v[210:211]
    v_pk_mul_f32 v[88:89], v[88:89], v[212:213]
    v_pk_mul_f32 v[90:91], v[90:91], v[214:215]
    v_exp_f32 v84, v84
    v_exp_f32 v85, v85
    v_exp_f32 v86, v86
    v_exp_f32 v87, v87
    v_exp_f32 v88, v88
    v_exp_f32 v89, v89
    v_exp_f32 v90, v90
    v_exp_f32 v91, v91
    v_pk_fma_f32 v[84:85], v[84:85], v[80:81], v[80:81] op_sel_hi:[1,0,0]
    v_pk_fma_f32 v[86:87], v[86:87], v[80:81], v[80:81] op_sel_hi:[1,0,0]
    v_pk_fma_f32 v[88:89], v[88:89], v[80:81], v[80:81] op_sel_hi:[1,0,0]
    v_pk_fma_f32 v[90:91], v[90:91], v[80:81], v[80:81] op_sel_hi:[1,0,0]
    v_rcp_f32 v84, v84
PD_M2_0_7:
    s_cbranch_execz PD_M2_0_8
    v_rcp_f32 v85, v85
    v_rcp_f32 v86, v86
    v_rcp_f32 v87, v87
    v_rcp_f32 v88, v88
    v_rcp_f32 v89, v89
    v_rcp_f32 v90, v90
    v_rcp_f32 v91, v91
    v_pk_mul_f32 v[84:85], v[84:85], v[208:209]
    v_pk_mul_f32 v[86:87], v[86:87], v[210:211]
    v_pk_mul_f32 v[88:89], v[88:89], v[212:213]
    v_pk_mul_f32 v[90:91], v[90:91], v[214:215]
    v_cvt_pk_bf16_f32 v16, v84, v85
    v_cvt_pk_bf16_f32 v17, v86, v87
    v_cvt_pk_bf16_f32 v18, v88, v89
    v_cvt_pk_bf16_f32 v19, v90, v91
    buffer_store_dwordx4 v[16:19], v3, s[12:15], s48 offen offset:1024 sc1
    v_pk_mul_f32 v[100:101], v[216:217], v[216:217]
    v_pk_mul_f32 v[102:103], v[218:219], v[218:219]
    v_pk_mul_f32 v[104:105], v[220:221], v[220:221]
PD_M2_0_8:
    s_cbranch_execz PD_M2_0_9
    v_pk_mul_f32 v[106:107], v[222:223], v[222:223]
    v_pk_fma_f32 v[100:101], v[100:101], v[78:79], v[76:77] op_sel_hi:[1,0,0]
    v_pk_fma_f32 v[102:103], v[102:103], v[78:79], v[76:77] op_sel_hi:[1,0,0]
    v_pk_fma_f32 v[104:105], v[104:105], v[78:79], v[76:77] op_sel_hi:[1,0,0]
    v_pk_fma_f32 v[106:107], v[106:107], v[78:79], v[76:77] op_sel_hi:[1,0,0]
    v_pk_mul_f32 v[100:101], v[100:101], v[216:217]
    v_pk_mul_f32 v[102:103], v[102:103], v[218:219]
    v_pk_mul_f32 v[104:105], v[104:105], v[220:221]
    v_pk_mul_f32 v[106:107], v[106:107], v[222:223]
    v_exp_f32 v100, v100
    v_exp_f32 v101, v101
    v_exp_f32 v102, v102
    v_exp_f32 v103, v103
    v_exp_f32 v104, v104
    v_exp_f32 v105, v105
    v_exp_f32 v106, v106
    v_exp_f32 v107, v107
    v_pk_fma_f32 v[100:101], v[100:101], v[80:81], v[80:81] op_sel_hi:[1,0,0]
    v_pk_fma_f32 v[102:103], v[102:103], v[80:81], v[80:81] op_sel_hi:[1,0,0]
    v_pk_fma_f32 v[104:105], v[104:105], v[80:81], v[80:81] op_sel_hi:[1,0,0]
PD_M2_0_9:
    s_cbranch_execz Lwarm_ret0
    v_pk_fma_f32 v[106:107], v[106:107], v[80:81], v[80:81] op_sel_hi:[1,0,0]
    v_rcp_f32 v100, v100
    v_rcp_f32 v101, v101
    v_rcp_f32 v102, v102
    v_rcp_f32 v103, v103
    v_rcp_f32 v104, v104
    v_rcp_f32 v105, v105
    v_rcp_f32 v106, v106
    v_rcp_f32 v107, v107
    v_pk_mul_f32 v[100:101], v[100:101], v[216:217]
    v_pk_mul_f32 v[102:103], v[102:103], v[218:219]
    v_pk_mul_f32 v[104:105], v[104:105], v[220:221]
    v_pk_mul_f32 v[106:107], v[106:107], v[222:223]
    v_cvt_pk_bf16_f32 v20, v100, v101
    v_cvt_pk_bf16_f32 v21, v102, v103
    v_cvt_pk_bf16_f32 v22, v104, v105
    v_cvt_pk_bf16_f32 v23, v106, v107
    buffer_store_dwordx4 v[20:23], v3, s[12:15], s48 offen offset:1280 sc1
    s_cmp_eq_u32 s40, 6
    s_cbranch_scc1 L1_mlpdone
CH_M3_0:
    s_cbranch_execz PD_M3_0_1
    v_pk_mul_f32 v[84:85], v[224:225], v[224:225]
    v_pk_mul_f32 v[86:87], v[226:227], v[226:227]
    v_pk_mul_f32 v[88:89], v[228:229], v[228:229]
    v_pk_mul_f32 v[90:91], v[230:231], v[230:231]
    v_pk_fma_f32 v[84:85], v[84:85], v[78:79], v[76:77] op_sel_hi:[1,0,0]
    v_pk_fma_f32 v[86:87], v[86:87], v[78:79], v[76:77] op_sel_hi:[1,0,0]
    v_pk_fma_f32 v[88:89], v[88:89], v[78:79], v[76:77] op_sel_hi:[1,0,0]
    v_pk_fma_f32 v[90:91], v[90:91], v[78:79], v[76:77] op_sel_hi:[1,0,0]
    v_pk_mul_f32 v[84:85], v[84:85], v[224:225]
    v_pk_mul_f32 v[86:87], v[86:87], v[226:227]
    v_pk_mul_f32 v[88:89], v[88:89], v[228:229]
    v_pk_mul_f32 v[90:91], v[90:91], v[230:231]
    v_exp_f32 v84, v84
    v_exp_f32 v85, v85
    v_exp_f32 v86, v86
    v_exp_f32 v87, v87
    v_exp_f32 v88, v88
    v_exp_f32 v89, v89
    v_exp_f32 v90, v90
PD_M3_0_1:
    s_cbranch_execz PD_M3_0_2
    v_exp_f32 v91, v91
    v_pk_fma_f32 v[84:85], v[84:85], v[80:81], v[80:81] op_sel_hi:[1,0,0]
    v_pk_fma_f32 v[86:87], v[86:87], v[80:81], v[80:81] op_sel_hi:[1,0,0]
    v_pk_fma_f32 v[88:89], v[88:89], v[80:81], v[80:81] op_sel_hi:[1,0,0]
    v_pk_fma_f32 v[90:91], v[90:91], v[80:81], v[80:81] op_sel_hi:[1,0,0]
    v_rcp_f32 v84, v84
    v_rcp_f32 v85, v85
    v_rcp_f32 v86, v86
    v_rcp_f32 v87, v87
    v_rcp_f32 v88, v88
    v_rcp_f32 v89, v89
    v_rcp_f32 v90, v90
    v_rcp_f32 v91, v91
    v_pk_mul_f32 v[84:85], v[84:85], v[224:225]
    v_pk_mul_f32 v[86:87], v[86:87], v[226:227]
    v_pk_mul_f32 v[88:89], v[88:89], v[228:229]
    v_pk_mul_f32 v[90:91], v[90:91], v[230:231]
    v_cvt_pk_bf16_f32 v8, v84, v85
    v_cvt_pk_bf16_f32 v9, v86, v87
    v_cvt_pk_bf16_f32 v10, v88, v89
PD_M3_0_2:
    s_cbranch_execz PD_M3_0_3
    v_cvt_pk_bf16_f32 v11, v90, v91
    buffer_store_dwordx4 v[8:11], v3, s[12:15], s48 offen offset:2048 sc1
    v_pk_mul_f32 v[100:101], v[232:233], v[232:233]
    v_pk_mul_f32 v[102:103], v[234:235], v[234:235]
    v_pk_mul_f32 v[104:105], v[236:237], v[236:237]
    v_pk_mul_f32 v[106:107], v[238:239], v[238:239]
    v_pk_fma_f32 v[100:101], v[100:101], v[78:79], v[76:77] op_sel_hi:[1,0,0]
    v_pk_fma_f32 v[102:103], v[102:103], v[78:79], v[76:77] op_sel_hi:[1,0,0]
    v_pk_fma_f32 v[104:105], v[104:105], v[78:79], v[76:77] op_sel_hi:[1,0,0]
    v_pk_fma_f32 v[106:107], v[106:107], v[78:79], v[76:77] op_sel_hi:[1,0,0]
    v_pk_mul_f32 v[100:101], v[100:101], v[232:233]
    v_pk_mul_f32 v[102:103], v[102:103], v[234:235]
    v_pk_mul_f32 v[104:105], v[104:105], v[236:237]
    v_pk_mul_f32 v[106:107], v[106:107], v[238:239]
    v_exp_f32 v100, v100
    v_exp_f32 v101, v101
    v_exp_f32 v102, v102
PD_M3_0_3:
    s_cbranch_execz PD_M3_0_4
    v_exp_f32 v103, v103
    v_exp_f32 v104, v104
    v_exp_f32 v105, v105
    v_exp_f32 v106, v106
    v_exp_f32 v107, v107
    v_pk_fma_f32 v[100:101], v[100:101], v[80:81], v[80:81] op_sel_hi:[1,0,0]
    v_pk_fma_f32 v[102:103], v[102:103], v[80:81], v[80:81] op_sel_hi:[1,0,0]
    v_pk_fma_f32 v[104:105], v[104:105], v[80:81], v[80:81] op_sel_hi:[1,0,0]
    v_pk_fma_f32 v[106:107], v[106:107], v[80:81], v[80:81] op_sel_hi:[1,0,0]
    v_rcp_f32 v100, v100
    v_rcp_f32 v101, v101
    v_rcp_f32 v102, v102
    v_rcp_f32 v103, v103
    v_rcp_f32 v104, v104
    v_rcp_f32 v105, v105
    v_rcp_f32 v106, v106
    v_rcp_f32 v107, v107
    v_pk_mul_f32 v[100:101], v[100:101], v[232:233]
    v_pk_mul_f32 v[102:103], v[102:103], v[234:235]
    v_pk_mul_f32 v[104:105], v[104:105], v[236:237]
    v_pk_mul_f32 v[106:107], v[106:107], v[238:239]
    v_cvt_pk_bf16_f32 v12, v100, v101
PD_M3_0_4:
    s_cbranch_execz PD_M3_0_5
    v_cvt_pk_bf16_f32 v13, v102, v103
    v_cvt_pk_bf16_f32 v14, v104, v105
    v_cvt_pk_bf16_f32 v15, v106, v107
    buffer_store_dwordx4 v[12:15], v3, s[12:15], s48 offen offset:2304 sc1
    v_pk_mul_f32 v[84:85], v[240:241], v[240:241]
    v_pk_mul_f32 v[86:87], v[242:243], v[242:243]
    v_pk_mul_f32 v[88:89], v[244:245], v[244:245]
    v_pk_mul_f32 v[90:91], v[246:247], v[246:247]
    v_pk_fma_f32 v[84:85], v[84:85], v[78:79], v[76:77] op_sel_hi:[1,0,0]
    v_pk_fma_f32 v[86:87], v[86:87], v[78:79], v[76:77] op_sel_hi:[1,0,0]
    v_pk_fma_f32 v[88:89], v[88:89], v[78:79], v[76:77] op_sel_hi:[1,0,0]
    v_pk_fma_f32 v[90:91], v[90:91], v[78:79], v[76:77] op_sel_hi:[1,0,0]
    v_pk_mul_f32 v[84:85], v[84:85], v[240:241]
    v_pk_mul_f32 v[86:87], v[86:87], v[242:243]
    v_pk_mul_f32 v[88:89], v[88:89], v[244:245]
    v_pk_mul_f32 v[90:91], v[90:91], v[246:247]
PD_M3_0_5:
    s_cbranch_execz PD_M3_0_6
    v_exp_f32 v84, v84
    v_exp_f32 v85, v85
    v_exp_f32 v86, v86
    v_exp_f32 v87, v87
    v_exp_f32 v88, v88
    v_exp_f32 v89, v89
    v_exp_f32 v90, v90
    v_exp_f32 v91, v91
    v_pk_fma_f32 v[84:85], v[84:85], v[80:81], v[80:81] op_sel_hi:[1,0,0]
    v_pk_fma_f32 v[86:87], v[86:87], v[80:81], v[80:81] op_sel_hi:[1,0,0]
    v_pk_fma_f32 v[88:89], v[88:89], v[80:81], v[80:81] op_sel_hi:[1,0,0]
    v_pk_fma_f32 v[90:91], v[90:91], v[80:81], v[80:81] op_sel_hi:[1,0,0]
    v_rcp_f32 v84, v84
    v_rcp_f32 v85, v85
    v_rcp_f32 v86, v86
    v_rcp_f32 v87, v87
    v_rcp_f32 v88, v88
    v_rcp_f32 v89, v89
    v_rcp_f32 v90, v90
    v_rcp_f32 v91, v91
    v_pk_mul_f32 v[84:85], v[84:85], v[240:241]
    v_pk_mul_f32 v[86:87], v[86:87], v[242:243]
    v_pk_mul_f32 v[88:89], v[88:89], v[244:245]
PD_M3_0_6:
    s_cbranch_execz PD_M3_0_7
    v_pk_mul_f32 v[90:91], v[90:91], v[246:247]
    v_cvt_pk_bf16_f32 v16, v84, v85
    v_cvt_pk_bf16_f32 v17, v86, v87
    v_cvt_pk_bf16_f32 v18, v88, v89
    v_cvt_pk_bf16_f32 v19, v90, v91
    buffer_store_dwordx4 v[16:19], v3, s[12:15], s48 offen offset:3072 sc1
    v_pk_mul_f32 v[100:101], v[248:249], v[248:249]
    v_pk_mul_f32 v[102:103], v[250:251], v[250:251]
    v_pk_mul_f32 v[104:105], v[252:253], v[252:253]
    v_pk_mul_f32 v[106:107], v[254:255], v[254:255]
    v_pk_fma_f32 v[100:101], v[100:101], v[78:79], v[76:77] op_sel_hi:[1,0,0]
    v_pk_fma_f32 v[102:103], v[102:103], v[78:79], v[76:77] op_sel_hi:[1,0,0]
    v_pk_fma_f32 v[104:105], v[104:105], v[78:79], v[76:77] op_sel_hi:[1,0,0]
    v_pk_fma_f32 v[106:107], v[106:107], v[78:79], v[76:77] op_sel_hi:[1,0,0]
    v_pk_mul_f32 v[100:101], v[100:101], v[248:249]
    v_pk_mul_f32 v[102:103], v[102:103], v[250:251]
PD_M3_0_7:
    s_cbranch_execz PD_M3_0_8
    v_pk_mul_f32 v[104:105], v[104:105], v[252:253]
    v_pk_mul_f32 v[106:107], v[106:107], v[254:255]
    v_exp_f32 v100, v100
    v_exp_f32 v101, v101
    v_exp_f32 v102, v102
    v_exp_f32 v103, v103
    v_exp_f32 v104, v104
    v_exp_f32 v105, v105
    v_exp_f32 v106, v106
    v_exp_f32 v107, v107
    v_pk_fma_f32 v[100:101], v[100:101], v[80:81], v[80:81] op_sel_hi:[1,0,0]
    v_pk_fma_f32 v[102:103], v[102:103], v[80:81], v[80:81] op_sel_hi:[1,0,0]
    v_pk_fma_f32 v[104:105], v[104:105], v[80:81], v[80:81] op_sel_hi:[1,0,0]
    v_pk_fma_f32 v[106:107], v[106:107], v[80:81], v[80:81] op_sel_hi:[1,0,0]
    v_rcp_f32 v100, v100
    v_rcp_f32 v101, v101
    v_rcp_f32 v102, v102
    v_rcp_f32 v103, v103
    v_rcp_f32 v104, v104
    v_rcp_f32 v105, v105
    v_rcp_f32 v106, v106
    v_rcp_f32 v107, v107
    v_pk_mul_f32 v[100:101], v[100:101], v[248:249]
PD_M3_0_8:
    s_cbranch_execz CH_T
    v_pk_mul_f32 v[102:103], v[102:103], v[250:251]
    v_pk_mul_f32 v[104:105], v[104:105], v[252:253]
    v_pk_mul_f32 v[106:107], v[106:107], v[254:255]
    v_cvt_pk_bf16_f32 v20, v100, v101
    v_cvt_pk_bf16_f32 v21, v102, v103
    v_cvt_pk_bf16_f32 v22, v104, v105
    v_cvt_pk_bf16_f32 v23, v106, v107
    buffer_store_dwordx4 v[20:23], v3, s[12:15], s48 offen offset:3328 sc1
L1_mlpdone:
    s_branch L1_fin
L1_attn:
CH_Q0_0:
    s_cbranch_execz PD_Q0_0_1
    v_and_b32 v76, 31, v1
    s_lshl_b32 s47, s36, 5
    v_add_u32 v76, s47, v76
    v_lshrrev_b32 v77, 5, v1
    v_mul_u32_u24 v78, 11520, v77
    v_mul_u32_u24 v79, 25344, v77
    v_mul_u32_u24 v80, 80, v76
    v_add_u32 v78, v78, v80
    v_mul_u32_u24 v80, 176, v76
PD_Q0_0_1:
    s_cbranch_execz PD_Q0_0_2
    v_add_u32 v79, v79, v80
    v_add_u32 v78, 49152, v78
    v_add_u32 v79, 72192, v79
    s_and_b32 s47, s36, 1
    s_cmp_lt_u32 s36, 2
    s_cselect_b32 s48, 11520, 0
    s_cselect_b32 s49, 0, 25344
    s_add_u32 s48, s48, s49
    s_mul_i32 s47, s47, s48
    s_cmp_lt_u32 s36, 2
    s_cselect_b32 s48, 0, 23040
    s_add_u32 s47, s47, s48
    s_add_u32 s47, s47, 49152
    s_cmp_lt_u32 s36, 2
    s_cselect_b32 s48, 256, 0
    s_cselect_b32 s49, 0, 1792
    s_add_u32 s48, s48, s49
    v_lshlrev_b32 v80, 4, v1
    s_add_u32 s65, s63, 2
    s_mul_i32 s65, s65, 5120
    buffer_load_dwordx4 a[0:3], v125, s[12:15], s65 offen offset:0 sc1
PD_Q0_0_2:
    s_cbranch_execz PD_Q0_0_3
    v_add_u32 v80, s47, v80
    v_add_u32 v81, s48, v80
    s_lshr_b32 s48, s48, 5
    s_lshl_b32 s48, s48, 4
    v_add_u32 v82, s48, v80
    v_mov_b32 v84, 0
    v_mov_b32 v85, 0
    v_mov_b32 v86, 0
    v_mov_b32 v87, 0
    ds_write_b128 v80, v[84:87]
    ds_write_b128 v81, v[84:87]
    ds_write_b128 v82, v[84:87]
    v_pk_mul_f32 v[168:169], v[168:169], v[74:75] op_sel_hi:[1,0]
    v_pk_mul_f32 v[170:171], v[170:171], v[74:75] op_sel_hi:[1,0]
    v_pk_mul_f32 v[172:173], v[172:173], v[74:75] op_sel_hi:[1,0]
    v_pk_mul_f32 v[174:175], v[174:175], v[74:75] op_sel_hi:[1,0]
    v_pk_mul_f32 v[176:177], v[176:177], v[74:75] op_sel_hi:[1,0]
    v_pk_mul_f32 v[178:179], v[178:179], v[74:75] op_sel_hi:[1,0]
    v_pk_mul_f32 v[180:181], v[180:181], v[74:75] op_sel_hi:[1,0]
    v_pk_mul_f32 v[182:183], v[182:183], v[74:75] op_sel_hi:[1,0]
PD_Q0_0_3:
    s_cbranch_execz PD_Q0_0_4
    v_pk_mul_f32 v[184:185], v[184:185], v[74:75] op_sel_hi:[1,0]
    v_pk_mul_f32 v[186:187], v[186:187], v[74:75] op_sel_hi:[1,0]
    buffer_load_dwordx4 a[4:7], v125, s[12:15], s65 offen offset:1024 sc1
    v_pk_mul_f32 v[188:189], v[188:189], v[74:75] op_sel_hi:[1,0]
    v_pk_mul_f32 v[190:191], v[190:191], v[74:75] op_sel_hi:[1,0]
    v_pk_mul_f32 v[192:193], v[192:193], v[74:75] op_sel_hi:[1,0]
    v_pk_mul_f32 v[194:195], v[194:195], v[74:75] op_sel_hi:[1,0]
    v_pk_mul_f32 v[196:197], v[196:197], v[74:75] op_sel_hi:[1,0]
    v_pk_mul_f32 v[198:199], v[198:199], v[74:75] op_sel_hi:[1,0]
    v_pk_mul_f32 v[200:201], v[200:201], v[74:75] op_sel_hi:[1,0]
    v_pk_mul_f32 v[202:203], v[202:203], v[74:75] op_sel_hi:[1,0]
    v_pk_mul_f32 v[204:205], v[204:205], v[74:75] op_sel_hi:[1,0]
    v_pk_mul_f32 v[206:207], v[206:207], v[74:75] op_sel_hi:[1,0]
    v_cvt_pk_bf16_f32 v22, v168, v169
    v_cvt_pk_bf16_f32 v23, v170, v171
    v_cvt_pk_bf16_f32 v24, v172, v173
PD_Q0_0_4:
    s_cbranch_execz PD_Q0_0_5
    v_cvt_pk_bf16_f32 v25, v174, v175
    v_cvt_pk_bf16_f32 v26, v176, v177
    v_cvt_pk_bf16_f32 v27, v178, v179
    v_cvt_pk_bf16_f32 v28, v180, v181
    v_cvt_pk_bf16_f32 v29, v182, v183
    v_cvt_pk_bf16_f32 v30, v184, v185
    v_cvt_pk_bf16_f32 v31, v186, v187
    v_cvt_pk_bf16_f32 v32, v188, v189
    v_cvt_pk_bf16_f32 v33, v190, v191
    buffer_load_dwordx4 a[8:11], v125, s[12:15], s65 offen offset:2048 sc1
    v_cvt_pk_bf16_f32 v34, v192, v193
    v_cvt_pk_bf16_f32 v35, v194, v195
    v_cvt_pk_bf16_f32 v36, v196, v197
    v_cvt_pk_bf16_f32 v37, v198, v199
    v_cvt_pk_bf16_f32 v38, v200, v201
PD_Q0_0_5:
    s_cbranch_execz PD_Q0_0_6
    v_cvt_pk_bf16_f32 v39, v202, v203
    v_cvt_pk_bf16_f32 v40, v204, v205
    v_cvt_pk_bf16_f32 v41, v206, v207
    ds_write_b128 v78, v[22:25] offset:1280
    ds_write_b128 v78, v[26:29] offset:1296
    ds_write_b128 v78, v[30:33] offset:1312
    ds_write_b128 v78, v[34:37] offset:1328
    ds_write_b128 v78, v[38:41] offset:1344
    v_pk_mul_f32 v[208:209], v[208:209], v[74:75] op_sel_hi:[1,0]
    v_pk_mul_f32 v[210:211], v[210:211], v[74:75] op_sel_hi:[1,0]
    v_pk_mul_f32 v[212:213], v[212:213], v[74:75] op_sel_hi:[1,0]
    v_pk_mul_f32 v[214:215], v[214:215], v[74:75] op_sel_hi:[1,0]
    v_pk_mul_f32 v[216:217], v[216:217], v[74:75] op_sel_hi:[1,0]
    v_pk_mul_f32 v[218:219], v[218:219], v[74:75] op_sel_hi:[1,0]
    v_pk_mul_f32 v[220:221], v[220:221], v[74:75] op_sel_hi:[1,0]
    v_pk_mul_f32 v[222:223], v[222:223], v[74:75] op_sel_hi:[1,0]
PD_Q0_0_6:
    s_cbranch_execz PD_Q0_0_7
    v_pk_mul_f32 v[224:225], v[224:225], v[74:75] op_sel_hi:[1,0]
    buffer_load_dwordx4 a[12:15], v125, s[12:15], s65 offen offset:3072 sc1
    v_pk_mul_f32 v[226:227], v[226:227], v[74:75] op_sel_hi:[1,0]
    v_pk_mul_f32 v[228:229], v[228:229], v[74:75] op_sel_hi:[1,0]
    v_pk_mul_f32 v[230:231], v[230:231], v[74:75] op_sel_hi:[1,0]
    v_pk_mul_f32 v[232:233], v[232:233], v[74:75] op_sel_hi:[1,0]
    v_pk_mul_f32 v[234:235], v[234:235], v[74:75] op_sel_hi:[1,0]
    v_pk_mul_f32 v[236:237], v[236:237], v[74:75] op_sel_hi:[1,0]
    v_pk_mul_f32 v[238:239], v[238:239], v[74:75] op_sel_hi:[1,0]
    v_pk_mul_f32 v[240:241], v[240:241], v[74:75] op_sel_hi:[1,0]
    v_pk_mul_f32 v[242:243], v[242:243], v[74:75] op_sel_hi:[1,0]
    v_pk_mul_f32 v[244:245], v[244:245], v[74:75] op_sel_hi:[1,0]
    v_pk_mul_f32 v[246:247], v[246:247], v[74:75] op_sel_hi:[1,0]
    ds_write_b128 v79, v[208:211] offset:2816
    ds_write_b128 v79, v[212:215] offset:2832
PD_Q0_0_7:
    s_cbranch_execz PD_Q0_0_8
    ds_write_b128 v79, v[216:219] offset:2848
    ds_write_b128 v79, v[220:223] offset:2864
    ds_write_b128 v79, v[224:227] offset:2880
    ds_write_b128 v79, v[228:231] offset:2896
    ds_write_b128 v79, v[232:235] offset:2912
    ds_write_b128 v79, v[236:239] offset:2928
    ds_write_b128 v79, v[240:243] offset:2944
    ds_write_b128 v79, v[244:247] offset:2960
    v_cvt_pk_bf16_f32 v2, v128, v129
    buffer_load_dwordx4 a[16:19], v126, s[12:15], s65 offen offset:0 sc1
    v_cvt_pk_bf16_f32 v3, v130, v131
    v_cvt_pk_bf16_f32 v4, v132, v133
    v_cvt_pk_bf16_f32 v5, v134, v135
    v_cvt_pk_bf16_f32 v6, v136, v137
    v_cvt_pk_bf16_f32 v7, v138, v139
    v_cvt_pk_bf16_f32 v8, v140, v141
PD_Q0_0_8:
    s_cbranch_execz PD_Q0_0_9
    v_cvt_pk_bf16_f32 v9, v142, v143
    v_cvt_pk_bf16_f32 v10, v144, v145
    v_cvt_pk_bf16_f32 v11, v146, v147
    v_cvt_pk_bf16_f32 v12, v148, v149
    v_cvt_pk_bf16_f32 v13, v150, v151
    v_cvt_pk_bf16_f32 v14, v152, v153
    v_cvt_pk_bf16_f32 v15, v154, v155
    v_cvt_pk_bf16_f32 v16, v156, v157
    v_cvt_pk_bf16_f32 v17, v158, v159
    v_cvt_pk_bf16_f32 v18, v160, v161
    v_cvt_pk_bf16_f32 v19, v162, v163
    v_cvt_pk_bf16_f32 v20, v164, v165
    v_cvt_pk_bf16_f32 v21, v166, v167
    v_mov_b32 v44, 0
    v_mov_b32 v45, 0
    v_mov_b32 v46, 0
    s_add_u32 s65, s63, 3
PD_Q0_0_9:
    s_cbranch_execz Lwarm_ret0
    s_mul_i32 s65, s65, 5120
    buffer_load_dwordx4 a[20:23], v125, s[12:15], s65 offen offset:0 sc1
    v_mov_b32 v47, 0
    v_mov_b32 v48, 0
    v_mov_b32 v49, 0
    v_mov_b32 v50, 0
    v_mov_b32 v51, 0
    v_mov_b32 v52, 0
    v_mov_b32 v53, 0
    v_mov_b32 v54, 0
    v_mov_b32 v55, 0
    v_mov_b32 v56, 0
    v_mov_b32 v57, 0
    v_mov_b32 v58, 0
    v_mov_b32 v59, 0
    s_waitcnt lgkmcnt(0)
    s_barrier
    ds_read_b128 v[148:151], v78 offset:1120
    ds_read_b128 v[152:155], v78 offset:1136
    ds_read_b128 v[156:159], v78 offset:1152
    ds_read_b128 v[160:163], v78 offset:1168
    ds_read_b128 v[164:167], v78 offset:1184
    ds_read_b128 v[168:171], v78 offset:960
CH_Q1_0:
    s_cbranch_execz PD_Q1_0_1
    ds_read_b128 v[172:175], v78 offset:976
    ds_read_b128 v[176:179], v78 offset:992
    ds_read_b128 v[180:183], v78 offset:1008
    ds_read_b128 v[184:187], v78 offset:1024
    v_dot2c_f32_bf16 v44, v2, v22
    buffer_load_dwordx4 a[24:27], v125, s[12:15], s65 offen offset:1024 sc1
    v_dot2c_f32_bf16 v52, v12, v32
    v_dot2c_f32_bf16 v44, v3, v23
    v_dot2c_f32_bf16 v52, v13, v33
    v_dot2c_f32_bf16 v44, v4, v24
    v_dot2c_f32_bf16 v52, v14, v34
    v_dot2c_f32_bf16 v44, v5, v25
    v_dot2c_f32_bf16 v52, v15, v35
    v_dot2c_f32_bf16 v44, v6, v26
    v_dot2c_f32_bf16 v52, v16, v36
    v_dot2c_f32_bf16 v44, v7, v27
    v_dot2c_f32_bf16 v52, v17, v37
    v_dot2c_f32_bf16 v44, v8, v28
    buffer_load_dwordx4 a[28:31], v125, s[12:15], s65 offen offset:2048 sc1
    v_dot2c_f32_bf16 v52, v18, v38
    v_dot2c_f32_bf16 v44, v9, v29
    v_dot2c_f32_bf16 v52, v19, v39
    v_dot2c_f32_bf16 v44, v10, v30
    v_dot2c_f32_bf16 v52, v20, v40
    v_dot2c_f32_bf16 v44, v11, v31
PD_Q1_0_1:
    s_cbranch_execz PD_Q1_0_2
    v_dot2c_f32_bf16 v52, v21, v41
    ds_read_b128 v[128:131], v78 offset:800
    ds_read_b128 v[132:135], v78 offset:816
    ds_read_b128 v[136:139], v78 offset:832
    ds_read_b128 v[140:143], v78 offset:848
    ds_read_b128 v[144:147], v78 offset:864
    s_waitcnt lgkmcnt(10)
    v_dot2c_f32_bf16 v45, v2, v148
    buffer_load_dwordx4 a[32:35], v125, s[12:15], s65 offen offset:3072 sc1
    v_dot2c_f32_bf16 v53, v12, v158
    v_dot2c_f32_bf16 v45, v3, v149
    v_dot2c_f32_bf16 v53, v13, v159
    v_dot2c_f32_bf16 v45, v4, v150
    v_dot2c_f32_bf16 v53, v14, v160
    v_dot2c_f32_bf16 v45, v5, v151
    v_dot2c_f32_bf16 v53, v15, v161
    v_dot2c_f32_bf16 v45, v6, v152
    v_dot2c_f32_bf16 v53, v16, v162
    v_dot2c_f32_bf16 v45, v7, v153
    v_dot2c_f32_bf16 v53, v17, v163
    v_dot2c_f32_bf16 v45, v8, v154
    buffer_load_dwordx4 a[36:39], v126, s[12:15], s65 offen offset:0 sc1
    v_dot2c_f32_bf16 v53, v18, v164
    v_dot2c_f32_bf16 v45, v9, v155
PD_Q1_0_2:
    s_cbranch_execz PD_Q1_0_3
    v_dot2c_f32_bf16 v53, v19, v165
    v_dot2c_f32_bf16 v45, v10, v156
    v_dot2c_f32_bf16 v53, v20, v166
    v_dot2c_f32_bf16 v45, v11, v157
    v_dot2c_f32_bf16 v53, v21, v167
    ds_read_b128 v[148:151], v78 offset:640
    ds_read_b128 v[152:155], v78 offset:656
    ds_read_b128 v[156:159], v78 offset:672
    ds_read_b128 v[160:163], v78 offset:688
    ds_read_b128 v[164:167], v78 offset:704
    s_waitcnt lgkmcnt(10)
    v_dot2c_f32_bf16 v46, v2, v168
    s_add_u32 s65, s63, 4
    s_mul_i32 s65, s65, 5120
    buffer_load_dwordx4 a[40:43], v125, s[12:15], s65 offen offset:0 sc1
    v_dot2c_f32_bf16 v54, v12, v178
    v_dot2c_f32_bf16 v46, v3, v169
    v_dot2c_f32_bf16 v54, v13, v179
    v_dot2c_f32_bf16 v46, v4, v170
    v_dot2c_f32_bf16 v54, v14, v180
    v_dot2c_f32_bf16 v46, v5, v171
    v_dot2c_f32_bf16 v54, v15, v181
    v_dot2c_f32_bf16 v46, v6, v172
    v_dot2c_f32_bf16 v54, v16, v182
PD_Q1_0_3:
    s_cbranch_execz PD_Q1_0_4
    v_dot2c_f32_bf16 v46, v7, v173
    v_dot2c_f32_bf16 v54, v17, v183
    v_dot2c_f32_bf16 v46, v8, v174
    buffer_load_dwordx4 a[44:47], v125, s[12:15], s65 offen offset:1024 sc1
    v_dot2c_f32_bf16 v54, v18, v184
    v_dot2c_f32_bf16 v46, v9, v175
    v_dot2c_f32_bf16 v54, v19, v185
    v_dot2c_f32_bf16 v46, v10, v176
    v_dot2c_f32_bf16 v54, v20, v186
    v_dot2c_f32_bf16 v46, v11, v177
    v_dot2c_f32_bf16 v54, v21, v187
    ds_read_b128 v[168:171], v78 offset:480
    ds_read_b128 v[172:175], v78 offset:496
    ds_read_b128 v[176:179], v78 offset:512
    ds_read_b128 v[180:183], v78 offset:528
    ds_read_b128 v[184:187], v78 offset:544
    s_waitcnt lgkmcnt(10)
    v_dot2c_f32_bf16 v47, v2, v128
    buffer_load_dwordx4 a[48:51], v125, s[12:15], s65 offen offset:2048 sc1
    v_dot2c_f32_bf16 v55, v12, v138
    v_dot2c_f32_bf16 v47, v3, v129
    v_dot2c_f32_bf16 v55, v13, v139
    v_dot2c_f32_bf16 v47, v4, v130
    v_dot2c_f32_bf16 v55, v14, v140
PD_Q1_0_4:
    s_cbranch_execz PD_Q1_0_5
    v_dot2c_f32_bf16 v47, v5, v131
    v_dot2c_f32_bf16 v55, v15, v141
    v_dot2c_f32_bf16 v47, v6, v132
    v_dot2c_f32_bf16 v55, v16, v142
    v_dot2c_f32_bf16 v47, v7, v133
    v_dot2c_f32_bf16 v55, v17, v143
    v_dot2c_f32_bf16 v47, v8, v134
    buffer_load_dwordx4 a[52:55], v125, s[12:15], s65 offen offset:3072 sc1
    v_dot2c_f32_bf16 v55, v18, v144
    v_dot2c_f32_bf16 v47, v9, v135
    v_dot2c_f32_bf16 v55, v19, v145
    v_dot2c_f32_bf16 v47, v10, v136
    v_dot2c_f32_bf16 v55, v20, v146
    v_dot2c_f32_bf16 v47, v11, v137
    v_dot2c_f32_bf16 v55, v21, v147
    ds_read_b128 v[128:131], v78 offset:320
    ds_read_b128 v[132:135], v78 offset:336
    ds_read_b128 v[136:139], v78 offset:352
    ds_read_b128 v[140:143], v78 offset:368
    ds_read_b128 v[144:147], v78 offset:384
    s_waitcnt lgkmcnt(10)
    v_dot2c_f32_bf16 v48, v2, v148
    buffer_load_dwordx4 a[56:59], v126, s[12:15], s65 offen offset:0 sc1
    v_dot2c_f32_bf16 v56, v12, v158
PD_Q1_0_5:
    s_cbranch_execz PD_Q1_0_6
    v_dot2c_f32_bf16 v48, v3, v149
    v_dot2c_f32_bf16 v56, v13, v159
    v_dot2c_f32_bf16 v48, v4, v150
    v_dot2c_f32_bf16 v56, v14, v160
    v_dot2c_f32_bf16 v48, v5, v151
    v_dot2c_f32_bf16 v56, v15, v161
    v_dot2c_f32_bf16 v48, v6, v152
    v_dot2c_f32_bf16 v56, v16, v162
    v_dot2c_f32_bf16 v48, v7, v153
    v_dot2c_f32_bf16 v56, v17, v163
    v_dot2c_f32_bf16 v48, v8, v154
    s_add_u32 s65, s63, 5
    s_mul_i32 s65, s65, 5120
    buffer_load_dwordx4 a[60:63], v125, s[12:15], s65 offen offset:0 sc1
    v_dot2c_f32_bf16 v56, v18, v164
    v_dot2c_f32_bf16 v48, v9, v155
    v_dot2c_f32_bf16 v56, v19, v165
    v_dot2c_f32_bf16 v48, v10, v156
    v_dot2c_f32_bf16 v56, v20, v166
    v_dot2c_f32_bf16 v48, v11, v157
    v_dot2c_f32_bf16 v56, v21, v167
    ds_read_b128 v[148:151], v78 offset:160
    ds_read_b128 v[152:155], v78 offset:176
    ds_read_b128 v[156:159], v78 offset:192
    ds_read_b128 v[160:163], v78 offset:208
PD_Q1_0_6:
    s_cbranch_execz PD_Q1_0_7
    ds_read_b128 v[164:167], v78 offset:224
    s_waitcnt lgkmcnt(10)
    v_dot2c_f32_bf16 v49, v2, v168
    buffer_load_dwordx4 a[64:67], v125, s[12:15], s65 offen offset:1024 sc1
    v_dot2c_f32_bf16 v57, v12, v178
    v_dot2c_f32_bf16 v49, v3, v169
    v_dot2c_f32_bf16 v57, v13, v179
    v_dot2c_f32_bf16 v49, v4, v170
    v_dot2c_f32_bf16 v57, v14, v180
    v_dot2c_f32_bf16 v49, v5, v171
    v_dot2c_f32_bf16 v57, v15, v181
    v_dot2c_f32_bf16 v49, v6, v172
    v_dot2c_f32_bf16 v57, v16, v182
    v_dot2c_f32_bf16 v49, v7, v173
    v_dot2c_f32_bf16 v57, v17, v183
    v_dot2c_f32_bf16 v49, v8, v174
    buffer_load_dwordx4 a[68:71], v125, s[12:15], s65 offen offset:2048 sc1
    v_dot2c_f32_bf16 v57, v18, v184
    v_dot2c_f32_bf16 v49, v9, v175
    v_dot2c_f32_bf16 v57, v19, v185
    v_dot2c_f32_bf16 v49, v10, v176
    v_dot2c_f32_bf16 v57, v20, v186
    v_dot2c_f32_bf16 v49, v11, v177
    v_dot2c_f32_bf16 v57, v21, v187
    ds_read_b128 v[84:87], v79 offset:2112
    ds_read_b128 v[88:91], v79 offset:2128
PD_Q1_0_7:
    s_cbranch_execz PD_Q1_0_8
    ds_read_b128 v[92:95], v79 offset:2144
    ds_read_b128 v[96:99], v79 offset:2160
    ds_read_b128 v[100:103], v79 offset:2176
    ds_read_b128 v[104:107], v79 offset:2192
    ds_read_b128 v[108:111], v79 offset:2208
    ds_read_b128 v[112:115], v79 offset:2224
    ds_read_b128 v[116:119], v79 offset:2240
    ds_read_b128 v[120:123], v79 offset:2256
    s_waitcnt lgkmcnt(15)
    v_dot2c_f32_bf16 v50, v2, v128
    buffer_load_dwordx4 a[72:75], v125, s[12:15], s65 offen offset:3072 sc1
    v_dot2c_f32_bf16 v58, v12, v138
    v_dot2c_f32_bf16 v50, v3, v129
    v_dot2c_f32_bf16 v58, v13, v139
    v_dot2c_f32_bf16 v50, v4, v130
    v_dot2c_f32_bf16 v58, v14, v140
    v_dot2c_f32_bf16 v50, v5, v131
    v_dot2c_f32_bf16 v58, v15, v141
    v_dot2c_f32_bf16 v50, v6, v132
    v_dot2c_f32_bf16 v58, v16, v142
    v_dot2c_f32_bf16 v50, v7, v133
    v_dot2c_f32_bf16 v58, v17, v143
PD_Q1_0_8:
    s_cbranch_execz PD_Q1_0_9
    v_dot2c_f32_bf16 v50, v8, v134
    buffer_load_dwordx4 a[76:79], v126, s[12:15], s65 offen offset:0 sc1
    v_dot2c_f32_bf16 v58, v18, v144
    v_dot2c_f32_bf16 v50, v9, v135
    v_dot2c_f32_bf16 v58, v19, v145
    v_dot2c_f32_bf16 v50, v10, v136
    v_dot2c_f32_bf16 v58, v20, v146
    v_dot2c_f32_bf16 v50, v11, v137
    v_dot2c_f32_bf16 v58, v21, v147
    s_waitcnt lgkmcnt(10)
    v_dot2c_f32_bf16 v51, v2, v148
    v_dot2c_f32_bf16 v59, v12, v158
    v_dot2c_f32_bf16 v51, v3, v149
    v_dot2c_f32_bf16 v59, v13, v159
    s_add_u32 s65, s63, 6
    s_mul_i32 s65, s65, 5120
    buffer_load_dwordx4 a[80:83], v125, s[12:15], s65 offen offset:0 sc1
    v_dot2c_f32_bf16 v51, v4, v150
    v_dot2c_f32_bf16 v59, v14, v160
    v_dot2c_f32_bf16 v51, v5, v151
    v_dot2c_f32_bf16 v59, v15, v161
    v_dot2c_f32_bf16 v51, v6, v152
    v_dot2c_f32_bf16 v59, v16, v162
    v_dot2c_f32_bf16 v51, v7, v153
    v_dot2c_f32_bf16 v59, v17, v163
    v_dot2c_f32_bf16 v51, v8, v154
    v_dot2c_f32_bf16 v59, v18, v164
    v_dot2c_f32_bf16 v51, v9, v155
PD_Q1_0_9:
    s_cbranch_execz PD_Q1_0_10
    v_dot2c_f32_bf16 v59, v19, v165
    buffer_load_dwordx4 a[84:87], v125, s[12:15], s65 offen offset:1024 sc1
    v_dot2c_f32_bf16 v51, v10, v156
    v_dot2c_f32_bf16 v59, v20, v166
    v_dot2c_f32_bf16 v51, v11, v157
    v_dot2c_f32_bf16 v59, v21, v167
    ds_read_b128 v[128:131], v79 offset:2464
    ds_read_b128 v[132:135], v79 offset:2480
    ds_read_b128 v[136:139], v79 offset:2496
    ds_read_b128 v[140:143], v79 offset:2512
    ds_read_b128 v[144:147], v79 offset:2528
    ds_read_b128 v[148:151], v79 offset:2544
    ds_read_b128 v[152:155], v79 offset:2560
    ds_read_b128 v[156:159], v79 offset:2576
    ds_read_b128 v[160:163], v79 offset:2592
    ds_read_b128 v[164:167], v79 offset:2608
    v_mul_f32 v60, 0x3ea52b5c, v74
    buffer_load_dwordx4 a[88:91], v125, s[12:15], s65 offen offset:2048 sc1
PD_Q1_0_10:
    s_cbranch_execz Lwarm_ret0
    v_mov_b32 v61, 0xf149f2ca
    v_cmp_gt_u32 vcc, 2, v76
    s_nop 1
    v_cndmask_b32 v45, v45, v61, vcc
    v_cndmask_b32 v53, v53, v61, vcc
    v_cmp_gt_u32 vcc, 4, v76
    s_nop 1
    v_cndmask_b32 v46, v46, v61, vcc
    v_cndmask_b32 v54, v54, v61, vcc
    v_cmp_gt_u32 vcc, 6, v76
    s_nop 1
    v_cndmask_b32 v47, v47, v61, vcc
    v_cndmask_b32 v55, v55, v61, vcc
    v_cmp_gt_u32 vcc, 8, v76
    s_nop 1
    v_cndmask_b32 v48, v48, v61, vcc
    buffer_load_dwordx4 a[92:95], v125, s[12:15], s65 offen offset:3072 sc1
    v_cndmask_b32 v56, v56, v61, vcc
    v_cmp_gt_u32 vcc, 10, v76
    s_nop 1
    v_cndmask_b32 v49, v49, v61, vcc
    v_cndmask_b32 v57, v57, v61, vcc
    v_cmp_gt_u32 vcc, 12, v76
    s_nop 1
    v_cndmask_b32 v50, v50, v61, vcc
    v_cndmask_b32 v58, v58, v61, vcc
    v_cmp_gt_u32 vcc, 14, v76
    s_nop 1
    v_cndmask_b32 v51, v51, v61, vcc
CH_Q2_0:
    s_cbranch_execz PD_Q2_0_1
    v_cndmask_b32 v59, v59, v61, vcc
    v_max3_f32 v62, v44, v45, v46
    v_max3_f32 v62, v62, v47, v48
    buffer_load_dwordx4 a[96:99], v126, s[12:15], s65 offen offset:0 sc1
    v_max3_f32 v62, v62, v49, v50
    v_max_f32 v62, v62, v51
    v_mul_f32 v62, v62, v60
    v_max3_f32 v63, v52, v53, v54
    v_max3_f32 v63, v63, v55, v56
    v_max3_f32 v63, v63, v57, v58
    v_max_f32 v63, v63, v59
    v_mul_f32 v63, v63, v60
    v_fma_f32 v44, v44, v60, -v62
    v_fma_f32 v45, v45, v60, -v62
    v_fma_f32 v46, v46, v60, -v62
    v_fma_f32 v47, v47, v60, -v62
    s_add_u32 s65, s63, 7
    s_mul_i32 s65, s65, 5120
    s_add_u32 m0, s68, 0
PD_Q2_0_1:
    s_cbranch_execz PD_Q2_0_2
    s_nop 0
    buffer_load_dwordx4 v125, s[12:15], s65 offen offset:0 sc1 lds
    v_fma_f32 v48, v48, v60, -v62
    v_fma_f32 v49, v49, v60, -v62
    v_fma_f32 v50, v50, v60, -v62
    v_fma_f32 v51, v51, v60, -v62
    v_fma_f32 v52, v52, v60, -v63
    v_fma_f32 v53, v53, v60, -v63
    v_fma_f32 v54, v54, v60, -v63
    v_fma_f32 v55, v55, v60, -v63
    v_fma_f32 v56, v56, v60, -v63
    v_fma_f32 v57, v57, v60, -v63
    v_fma_f32 v58, v58, v60, -v63
    v_fma_f32 v59, v59, v60, -v63
    buffer_load_dwordx4 v125, s[12:15], s65 offen offset:1024 sc1 lds
    v_exp_f32 v44, v44
    v_exp_f32 v45, v45
PD_Q2_0_2:
    s_cbranch_execz PD_Q2_0_3
    v_exp_f32 v46, v46
    v_exp_f32 v47, v47
    v_exp_f32 v48, v48
    v_exp_f32 v49, v49
    v_exp_f32 v50, v50
    v_exp_f32 v51, v51
    v_exp_f32 v52, v52
    v_exp_f32 v53, v53
    v_exp_f32 v54, v54
    v_exp_f32 v55, v55
    buffer_load_dwordx4 v125, s[12:15], s65 offen offset:2048 sc1 lds
    v_exp_f32 v56, v56
    v_exp_f32 v57, v57
    v_exp_f32 v58, v58
    v_exp_f32 v59, v59
    v_add_f32 v62, v44, v45
    v_add_f32 v62, v62, v46
    v_add_f32 v62, v62, v47
    v_add_f32 v62, v62, v48
    v_add_f32 v62, v62, v49
    v_add_f32 v62, v62, v50
    v_add_f32 v62, v62, v51
    v_add_f32 v63, v52, v53
    buffer_load_dwordx4 v125, s[12:15], s65 offen offset:3072 sc1 lds
    v_add_f32 v63, v63, v54
    v_add_f32 v63, v63, v55
    v_add_f32 v63, v63, v56
    v_add_f32 v63, v63, v57
    v_add_f32 v63, v63, v58
PD_Q2_0_3:
    s_cbranch_execz PD_Q2_0_4
    v_add_f32 v63, v63, v59
    v_rcp_f32 v62, v62
    v_rcp_f32 v63, v63
    v_mul_f32 v44, v44, v62
    v_mul_f32 v45, v45, v62
    v_mul_f32 v46, v46, v62
    v_mul_f32 v47, v47, v62
    s_add_u32 m0, s68, 4096
    s_nop 0
    buffer_load_dwordx4 v126, s[12:15], s65 offen sc1 lds
    v_mul_f32 v48, v48, v62
    v_mul_f32 v49, v49, v62
    v_mul_f32 v50, v50, v62
    v_mul_f32 v51, v51, v62
    v_mul_f32 v52, v52, v63
    v_mul_f32 v53, v53, v63
    v_mul_f32 v54, v54, v63
    v_mul_f32 v55, v55, v63
    v_mul_f32 v56, v56, v63
    v_mul_f32 v57, v57, v63
    v_mul_f32 v58, v58, v63
    v_mul_f32 v59, v59, v63
    s_add_u32 s65, s63, 8
    s_mul_i32 s65, s65, 5120
    s_add_u32 m0, s68, 5120
    s_nop 0
    buffer_load_dwordx4 v125, s[12:15], s65 offen offset:0 sc1 lds
PD_Q2_0_4:
    s_cbranch_execz PD_Q2_0_5
    v_pk_mul_f32 v[2:3], v[208:209], v[44:45] op_sel:[0,0] op_sel_hi:[1,0]
    v_pk_mul_f32 v[4:5], v[210:211], v[44:45] op_sel:[0,0] op_sel_hi:[1,0]
    v_pk_mul_f32 v[6:7], v[212:213], v[44:45] op_sel:[0,0] op_sel_hi:[1,0]
    v_pk_mul_f32 v[8:9], v[214:215], v[44:45] op_sel:[0,0] op_sel_hi:[1,0]
    v_pk_mul_f32 v[10:11], v[216:217], v[44:45] op_sel:[0,0] op_sel_hi:[1,0]
    v_pk_mul_f32 v[12:13], v[218:219], v[44:45] op_sel:[0,0] op_sel_hi:[1,0]
    v_pk_mul_f32 v[14:15], v[220:221], v[44:45] op_sel:[0,0] op_sel_hi:[1,0]
    v_pk_mul_f32 v[16:17], v[222:223], v[44:45] op_sel:[0,0] op_sel_hi:[1,0]
    v_pk_mul_f32 v[18:19], v[224:225], v[44:45] op_sel:[0,0] op_sel_hi:[1,0]
    v_pk_mul_f32 v[20:21], v[226:227], v[44:45] op_sel:[0,0] op_sel_hi:[1,0]
    v_pk_mul_f32 v[22:23], v[228:229], v[52:53] op_sel:[0,0] op_sel_hi:[1,0]
    v_pk_mul_f32 v[24:25], v[230:231], v[52:53] op_sel:[0,0] op_sel_hi:[1,0]
    buffer_load_dwordx4 v125, s[12:15], s65 offen offset:1024 sc1 lds
    v_pk_mul_f32 v[26:27], v[232:233], v[52:53] op_sel:[0,0] op_sel_hi:[1,0]
    v_pk_mul_f32 v[28:29], v[234:235], v[52:53] op_sel:[0,0] op_sel_hi:[1,0]
PD_Q2_0_5:
    s_cbranch_execz PD_Q2_0_6
    v_pk_mul_f32 v[30:31], v[236:237], v[52:53] op_sel:[0,0] op_sel_hi:[1,0]
    v_pk_mul_f32 v[32:33], v[238:239], v[52:53] op_sel:[0,0] op_sel_hi:[1,0]
    v_pk_mul_f32 v[34:35], v[240:241], v[52:53] op_sel:[0,0] op_sel_hi:[1,0]
    v_pk_mul_f32 v[36:37], v[242:243], v[52:53] op_sel:[0,0] op_sel_hi:[1,0]
    v_pk_mul_f32 v[38:39], v[244:245], v[52:53] op_sel:[0,0] op_sel_hi:[1,0]
    v_pk_mul_f32 v[40:41], v[246:247], v[52:53] op_sel:[0,0] op_sel_hi:[1,0]
    s_waitcnt lgkmcnt(10)
    v_pk_fma_f32 v[2:3], v[84:85], v[46:47], v[2:3] op_sel:[0,0,0] op_sel_hi:[1,0,1]
    v_pk_fma_f32 v[4:5], v[86:87], v[46:47], v[4:5] op_sel:[0,0,0] op_sel_hi:[1,0,1]
    v_pk_fma_f32 v[6:7], v[88:89], v[46:47], v[6:7] op_sel:[0,0,0] op_sel_hi:[1,0,1]
    buffer_load_dwordx4 v125, s[12:15], s65 offen offset:2048 sc1 lds
    v_pk_fma_f32 v[8:9], v[90:91], v[46:47], v[8:9] op_sel:[0,0,0] op_sel_hi:[1,0,1]
    v_pk_fma_f32 v[10:11], v[92:93], v[46:47], v[10:11] op_sel:[0,0,0] op_sel_hi:[1,0,1]
    v_pk_fma_f32 v[12:13], v[94:95], v[46:47], v[12:13] op_sel:[0,0,0] op_sel_hi:[1,0,1]
    v_pk_fma_f32 v[14:15], v[96:97], v[46:47], v[14:15] op_sel:[0,0,0] op_sel_hi:[1,0,1]
    v_pk_fma_f32 v[16:17], v[98:99], v[46:47], v[16:17] op_sel:[0,0,0] op_sel_hi:[1,0,1]
PD_Q2_0_6:
    s_cbranch_execz PD_Q2_0_7
    v_pk_fma_f32 v[18:19], v[100:101], v[46:47], v[18:19] op_sel:[0,0,0] op_sel_hi:[1,0,1]
    v_pk_fma_f32 v[20:21], v[102:103], v[46:47], v[20:21] op_sel:[0,0,0] op_sel_hi:[1,0,1]
    v_pk_fma_f32 v[22:23], v[104:105], v[54:55], v[22:23] op_sel:[0,0,0] op_sel_hi:[1,0,1]
    v_pk_fma_f32 v[24:25], v[106:107], v[54:55], v[24:25] op_sel:[0,0,0] op_sel_hi:[1,0,1]
    v_pk_fma_f32 v[26:27], v[108:109], v[54:55], v[26:27] op_sel:[0,0,0] op_sel_hi:[1,0,1]
    v_pk_fma_f32 v[28:29], v[110:111], v[54:55], v[28:29] op_sel:[0,0,0] op_sel_hi:[1,0,1]
    v_pk_fma_f32 v[30:31], v[112:113], v[54:55], v[30:31] op_sel:[0,0,0] op_sel_hi:[1,0,1]
    buffer_load_dwordx4 v125, s[12:15], s65 offen offset:3072 sc1 lds
    v_pk_fma_f32 v[32:33], v[114:115], v[54:55], v[32:33] op_sel:[0,0,0] op_sel_hi:[1,0,1]
    v_pk_fma_f32 v[34:35], v[116:117], v[54:55], v[34:35] op_sel:[0,0,0] op_sel_hi:[1,0,1]
    v_pk_fma_f32 v[36:37], v[118:119], v[54:55], v[36:37] op_sel:[0,0,0] op_sel_hi:[1,0,1]
    v_pk_fma_f32 v[38:39], v[120:121], v[54:55], v[38:39] op_sel:[0,0,0] op_sel_hi:[1,0,1]
    v_pk_fma_f32 v[40:41], v[122:123], v[54:55], v[40:41] op_sel:[0,0,0] op_sel_hi:[1,0,1]
    ds_read_b128 v[84:87], v79 offset:1408
    ds_read_b128 v[88:91], v79 offset:1424
    ds_read_b128 v[92:95], v79 offset:1440
PD_Q2_0_7:
    s_cbranch_execz PD_Q2_0_8
    ds_read_b128 v[96:99], v79 offset:1456
    ds_read_b128 v[100:103], v79 offset:1472
    ds_read_b128 v[104:107], v79 offset:1488
    ds_read_b128 v[108:111], v79 offset:1504
    ds_read_b128 v[112:115], v79 offset:1520
    ds_read_b128 v[116:119], v79 offset:1536
    ds_read_b128 v[120:123], v79 offset:1552
    s_waitcnt lgkmcnt(10)
    v_pk_fma_f32 v[2:3], v[128:129], v[44:45], v[2:3] op_sel:[0,1,0] op_sel_hi:[1,1,1]
    s_add_u32 m0, s68, 9216
    s_nop 0
    buffer_load_dwordx4 v126, s[12:15], s65 offen sc1 lds
    v_pk_fma_f32 v[4:5], v[130:131], v[44:45], v[4:5] op_sel:[0,1,0] op_sel_hi:[1,1,1]
    v_pk_fma_f32 v[6:7], v[132:133], v[44:45], v[6:7] op_sel:[0,1,0] op_sel_hi:[1,1,1]
    v_pk_fma_f32 v[8:9], v[134:135], v[44:45], v[8:9] op_sel:[0,1,0] op_sel_hi:[1,1,1]
    v_pk_fma_f32 v[10:11], v[136:137], v[44:45], v[10:11] op_sel:[0,1,0] op_sel_hi:[1,1,1]
PD_Q2_0_8:
    s_cbranch_execz PD_Q2_0_9
    v_pk_fma_f32 v[12:13], v[138:139], v[44:45], v[12:13] op_sel:[0,1,0] op_sel_hi:[1,1,1]
    v_pk_fma_f32 v[14:15], v[140:141], v[44:45], v[14:15] op_sel:[0,1,0] op_sel_hi:[1,1,1]
    v_pk_fma_f32 v[16:17], v[142:143], v[44:45], v[16:17] op_sel:[0,1,0] op_sel_hi:[1,1,1]
    v_pk_fma_f32 v[18:19], v[144:145], v[44:45], v[18:19] op_sel:[0,1,0] op_sel_hi:[1,1,1]
    v_pk_fma_f32 v[20:21], v[146:147], v[44:45], v[20:21] op_sel:[0,1,0] op_sel_hi:[1,1,1]
    v_pk_fma_f32 v[22:23], v[148:149], v[52:53], v[22:23] op_sel:[0,1,0] op_sel_hi:[1,1,1]
    v_pk_fma_f32 v[24:25], v[150:151], v[52:53], v[24:25] op_sel:[0,1,0] op_sel_hi:[1,1,1]
    v_pk_fma_f32 v[26:27], v[152:153], v[52:53], v[26:27] op_sel:[0,1,0] op_sel_hi:[1,1,1]
    s_add_u32 s65, s63, 9
    s_mul_i32 s65, s65, 5120
    s_add_u32 m0, s68, 122880
    s_nop 0
    buffer_load_dwordx4 v125, s[12:15], s65 offen offset:0 sc1 lds
    v_pk_fma_f32 v[28:29], v[154:155], v[52:53], v[28:29] op_sel:[0,1,0] op_sel_hi:[1,1,1]
    v_pk_fma_f32 v[30:31], v[156:157], v[52:53], v[30:31] op_sel:[0,1,0] op_sel_hi:[1,1,1]
    v_pk_fma_f32 v[32:33], v[158:159], v[52:53], v[32:33] op_sel:[0,1,0] op_sel_hi:[1,1,1]
    v_pk_fma_f32 v[34:35], v[160:161], v[52:53], v[34:35] op_sel:[0,1,0] op_sel_hi:[1,1,1]
PD_Q2_0_9:
    s_cbranch_execz PD_Q2_0_10
    v_pk_fma_f32 v[36:37], v[162:163], v[52:53], v[36:37] op_sel:[0,1,0] op_sel_hi:[1,1,1]
    v_pk_fma_f32 v[38:39], v[164:165], v[52:53], v[38:39] op_sel:[0,1,0] op_sel_hi:[1,1,1]
    v_pk_fma_f32 v[40:41], v[166:167], v[52:53], v[40:41] op_sel:[0,1,0] op_sel_hi:[1,1,1]
    ds_read_b128 v[128:131], v79 offset:1760
    ds_read_b128 v[132:135], v79 offset:1776
    ds_read_b128 v[136:139], v79 offset:1792
    ds_read_b128 v[140:143], v79 offset:1808
    ds_read_b128 v[144:147], v79 offset:1824
    ds_read_b128 v[148:151], v79 offset:1840
    ds_read_b128 v[152:155], v79 offset:1856
    ds_read_b128 v[156:159], v79 offset:1872
    ds_read_b128 v[160:163], v79 offset:1888
    ds_read_b128 v[164:167], v79 offset:1904
    s_waitcnt lgkmcnt(10)
    v_pk_fma_f32 v[2:3], v[84:85], v[48:49], v[2:3] op_sel:[0,0,0] op_sel_hi:[1,0,1]
    buffer_load_dwordx4 v125, s[12:15], s65 offen offset:1024 sc1 lds
PD_Q2_0_10:
    s_cbranch_execz Lwarm_ret0
    v_pk_fma_f32 v[4:5], v[86:87], v[48:49], v[4:5] op_sel:[0,0,0] op_sel_hi:[1,0,1]
    v_pk_fma_f32 v[6:7], v[88:89], v[48:49], v[6:7] op_sel:[0,0,0] op_sel_hi:[1,0,1]
    v_pk_fma_f32 v[8:9], v[90:91], v[48:49], v[8:9] op_sel:[0,0,0] op_sel_hi:[1,0,1]
    v_pk_fma_f32 v[10:11], v[92:93], v[48:49], v[10:11] op_sel:[0,0,0] op_sel_hi:[1,0,1]
    v_pk_fma_f32 v[12:13], v[94:95], v[48:49], v[12:13] op_sel:[0,0,0] op_sel_hi:[1,0,1]
    v_pk_fma_f32 v[14:15], v[96:97], v[48:49], v[14:15] op_sel:[0,0,0] op_sel_hi:[1,0,1]
    v_pk_fma_f32 v[16:17], v[98:99], v[48:49], v[16:17] op_sel:[0,0,0] op_sel_hi:[1,0,1]
    v_pk_fma_f32 v[18:19], v[100:101], v[48:49], v[18:19] op_sel:[0,0,0] op_sel_hi:[1,0,1]
    v_pk_fma_f32 v[20:21], v[102:103], v[48:49], v[20:21] op_sel:[0,0,0] op_sel_hi:[1,0,1]
    v_pk_fma_f32 v[22:23], v[104:105], v[56:57], v[22:23] op_sel:[0,0,0] op_sel_hi:[1,0,1]
    v_pk_fma_f32 v[24:25], v[106:107], v[56:57], v[24:25] op_sel:[0,0,0] op_sel_hi:[1,0,1]
    v_pk_fma_f32 v[26:27], v[108:109], v[56:57], v[26:27] op_sel:[0,0,0] op_sel_hi:[1,0,1]
    buffer_load_dwordx4 v125, s[12:15], s65 offen offset:2048 sc1 lds
    v_pk_fma_f32 v[28:29], v[110:111], v[56:57], v[28:29] op_sel:[0,0,0] op_sel_hi:[1,0,1]
    v_pk_fma_f32 v[30:31], v[112:113], v[56:57], v[30:31] op_sel:[0,0,0] op_sel_hi:[1,0,1]
CH_Q3_0:
    s_cbranch_execz PD_Q3_0_1
    v_pk_fma_f32 v[32:33], v[114:115], v[56:57], v[32:33] op_sel:[0,0,0] op_sel_hi:[1,0,1]
    v_pk_fma_f32 v[34:35], v[116:117], v[56:57], v[34:35] op_sel:[0,0,0] op_sel_hi:[1,0,1]
    v_pk_fma_f32 v[36:37], v[118:119], v[56:57], v[36:37] op_sel:[0,0,0] op_sel_hi:[1,0,1]
    v_pk_fma_f32 v[38:39], v[120:121], v[56:57], v[38:39] op_sel:[0,0,0] op_sel_hi:[1,0,1]
    v_pk_fma_f32 v[40:41], v[122:123], v[56:57], v[40:41] op_sel:[0,0,0] op_sel_hi:[1,0,1]
    ds_read_b128 v[84:87], v79 offset:704
    ds_read_b128 v[88:91], v79 offset:720
    ds_read_b128 v[92:95], v79 offset:736
    ds_read_b128 v[96:99], v79 offset:752
    ds_read_b128 v[100:103], v79 offset:768
    ds_read_b128 v[104:107], v79 offset:784
    ds_read_b128 v[108:111], v79 offset:800
    ds_read_b128 v[112:115], v79 offset:816
    ds_read_b128 v[116:119], v79 offset:832
    ds_read_b128 v[120:123], v79 offset:848
    s_waitcnt lgkmcnt(10)
PD_Q3_0_1:
    s_cbranch_execz PD_Q3_0_2
    v_pk_fma_f32 v[2:3], v[128:129], v[46:47], v[2:3] op_sel:[0,1,0] op_sel_hi:[1,1,1]
    buffer_load_dwordx4 v125, s[12:15], s65 offen offset:3072 sc1 lds
    v_pk_fma_f32 v[4:5], v[130:131], v[46:47], v[4:5] op_sel:[0,1,0] op_sel_hi:[1,1,1]
    v_pk_fma_f32 v[6:7], v[132:133], v[46:47], v[6:7] op_sel:[0,1,0] op_sel_hi:[1,1,1]
    v_pk_fma_f32 v[8:9], v[134:135], v[46:47], v[8:9] op_sel:[0,1,0] op_sel_hi:[1,1,1]
    v_pk_fma_f32 v[10:11], v[136:137], v[46:47], v[10:11] op_sel:[0,1,0] op_sel_hi:[1,1,1]
    v_pk_fma_f32 v[12:13], v[138:139], v[46:47], v[12:13] op_sel:[0,1,0] op_sel_hi:[1,1,1]
    v_pk_fma_f32 v[14:15], v[140:141], v[46:47], v[14:15] op_sel:[0,1,0] op_sel_hi:[1,1,1]
    v_pk_fma_f32 v[16:17], v[142:143], v[46:47], v[16:17] op_sel:[0,1,0] op_sel_hi:[1,1,1]
    v_pk_fma_f32 v[18:19], v[144:145], v[46:47], v[18:19] op_sel:[0,1,0] op_sel_hi:[1,1,1]
    v_pk_fma_f32 v[20:21], v[146:147], v[46:47], v[20:21] op_sel:[0,1,0] op_sel_hi:[1,1,1]
    v_pk_fma_f32 v[22:23], v[148:149], v[54:55], v[22:23] op_sel:[0,1,0] op_sel_hi:[1,1,1]
    v_pk_fma_f32 v[24:25], v[150:151], v[54:55], v[24:25] op_sel:[0,1,0] op_sel_hi:[1,1,1]
    v_pk_fma_f32 v[26:27], v[152:153], v[54:55], v[26:27] op_sel:[0,1,0] op_sel_hi:[1,1,1]
    s_add_u32 m0, s68, 126976
    s_nop 0
PD_Q3_0_2:
    s_cbranch_execz PD_Q3_0_3
    buffer_load_dwordx4 v126, s[12:15], s65 offen sc1 lds
    v_pk_fma_f32 v[28:29], v[154:155], v[54:55], v[28:29] op_sel:[0,1,0] op_sel_hi:[1,1,1]
    v_pk_fma_f32 v[30:31], v[156:157], v[54:55], v[30:31] op_sel:[0,1,0] op_sel_hi:[1,1,1]
    v_pk_fma_f32 v[32:33], v[158:159], v[54:55], v[32:33] op_sel:[0,1,0] op_sel_hi:[1,1,1]
    v_pk_fma_f32 v[34:35], v[160:161], v[54:55], v[34:35] op_sel:[0,1,0] op_sel_hi:[1,1,1]
    v_pk_fma_f32 v[36:37], v[162:163], v[54:55], v[36:37] op_sel:[0,1,0] op_sel_hi:[1,1,1]
    v_pk_fma_f32 v[38:39], v[164:165], v[54:55], v[38:39] op_sel:[0,1,0] op_sel_hi:[1,1,1]
    v_pk_fma_f32 v[40:41], v[166:167], v[54:55], v[40:41] op_sel:[0,1,0] op_sel_hi:[1,1,1]
    ds_read_b128 v[128:131], v79 offset:1056
    ds_read_b128 v[132:135], v79 offset:1072
    ds_read_b128 v[136:139], v79 offset:1088
    ds_read_b128 v[140:143], v79 offset:1104
    ds_read_b128 v[144:147], v79 offset:1120
    ds_read_b128 v[148:151], v79 offset:1136
    ds_read_b128 v[152:155], v79 offset:1152
    ds_read_b128 v[156:159], v79 offset:1168
PD_Q3_0_3:
    s_cbranch_execz PD_Q3_0_4
    ds_read_b128 v[160:163], v79 offset:1184
    ds_read_b128 v[164:167], v79 offset:1200
    s_waitcnt lgkmcnt(10)
    v_pk_fma_f32 v[2:3], v[84:85], v[50:51], v[2:3] op_sel:[0,0,0] op_sel_hi:[1,0,1]
    v_pk_fma_f32 v[4:5], v[86:87], v[50:51], v[4:5] op_sel:[0,0,0] op_sel_hi:[1,0,1]
    v_pk_fma_f32 v[6:7], v[88:89], v[50:51], v[6:7] op_sel:[0,0,0] op_sel_hi:[1,0,1]
    v_pk_fma_f32 v[8:9], v[90:91], v[50:51], v[8:9] op_sel:[0,0,0] op_sel_hi:[1,0,1]
    v_pk_fma_f32 v[10:11], v[92:93], v[50:51], v[10:11] op_sel:[0,0,0] op_sel_hi:[1,0,1]
    v_pk_fma_f32 v[12:13], v[94:95], v[50:51], v[12:13] op_sel:[0,0,0] op_sel_hi:[1,0,1]
    v_pk_fma_f32 v[14:15], v[96:97], v[50:51], v[14:15] op_sel:[0,0,0] op_sel_hi:[1,0,1]
    v_pk_fma_f32 v[16:17], v[98:99], v[50:51], v[16:17] op_sel:[0,0,0] op_sel_hi:[1,0,1]
    v_pk_fma_f32 v[18:19], v[100:101], v[50:51], v[18:19] op_sel:[0,0,0] op_sel_hi:[1,0,1]
    v_pk_fma_f32 v[20:21], v[102:103], v[50:51], v[20:21] op_sel:[0,0,0] op_sel_hi:[1,0,1]
    v_pk_fma_f32 v[22:23], v[104:105], v[58:59], v[22:23] op_sel:[0,0,0] op_sel_hi:[1,0,1]
    v_pk_fma_f32 v[24:25], v[106:107], v[58:59], v[24:25] op_sel:[0,0,0] op_sel_hi:[1,0,1]
    v_pk_fma_f32 v[26:27], v[108:109], v[58:59], v[26:27] op_sel:[0,0,0] op_sel_hi:[1,0,1]
PD_Q3_0_4:
    s_cbranch_execz PD_Q3_0_5
    v_pk_fma_f32 v[28:29], v[110:111], v[58:59], v[28:29] op_sel:[0,0,0] op_sel_hi:[1,0,1]
    v_pk_fma_f32 v[30:31], v[112:113], v[58:59], v[30:31] op_sel:[0,0,0] op_sel_hi:[1,0,1]
    v_pk_fma_f32 v[32:33], v[114:115], v[58:59], v[32:33] op_sel:[0,0,0] op_sel_hi:[1,0,1]
    v_pk_fma_f32 v[34:35], v[116:117], v[58:59], v[34:35] op_sel:[0,0,0] op_sel_hi:[1,0,1]
    v_pk_fma_f32 v[36:37], v[118:119], v[58:59], v[36:37] op_sel:[0,0,0] op_sel_hi:[1,0,1]
    v_pk_fma_f32 v[38:39], v[120:121], v[58:59], v[38:39] op_sel:[0,0,0] op_sel_hi:[1,0,1]
    v_pk_fma_f32 v[40:41], v[122:123], v[58:59], v[40:41] op_sel:[0,0,0] op_sel_hi:[1,0,1]
    s_waitcnt lgkmcnt(0)
    v_pk_fma_f32 v[2:3], v[128:129], v[48:49], v[2:3] op_sel:[0,1,0] op_sel_hi:[1,1,1]
    v_pk_fma_f32 v[4:5], v[130:131], v[48:49], v[4:5] op_sel:[0,1,0] op_sel_hi:[1,1,1]
    v_pk_fma_f32 v[6:7], v[132:133], v[48:49], v[6:7] op_sel:[0,1,0] op_sel_hi:[1,1,1]
    v_pk_fma_f32 v[8:9], v[134:135], v[48:49], v[8:9] op_sel:[0,1,0] op_sel_hi:[1,1,1]
    v_pk_fma_f32 v[10:11], v[136:137], v[48:49], v[10:11] op_sel:[0,1,0] op_sel_hi:[1,1,1]
    v_pk_fma_f32 v[12:13], v[138:139], v[48:49], v[12:13] op_sel:[0,1,0] op_sel_hi:[1,1,1]
    v_pk_fma_f32 v[14:15], v[140:141], v[48:49], v[14:15] op_sel:[0,1,0] op_sel_hi:[1,1,1]
    v_pk_fma_f32 v[16:17], v[142:143], v[48:49], v[16:17] op_sel:[0,1,0] op_sel_hi:[1,1,1]
PD_Q3_0_5:
    s_cbranch_execz PD_Q3_0_6
    v_pk_fma_f32 v[18:19], v[144:145], v[48:49], v[18:19] op_sel:[0,1,0] op_sel_hi:[1,1,1]
    v_pk_fma_f32 v[20:21], v[146:147], v[48:49], v[20:21] op_sel:[0,1,0] op_sel_hi:[1,1,1]
    v_pk_fma_f32 v[22:23], v[148:149], v[56:57], v[22:23] op_sel:[0,1,0] op_sel_hi:[1,1,1]
    v_pk_fma_f32 v[24:25], v[150:151], v[56:57], v[24:25] op_sel:[0,1,0] op_sel_hi:[1,1,1]
    v_pk_fma_f32 v[26:27], v[152:153], v[56:57], v[26:27] op_sel:[0,1,0] op_sel_hi:[1,1,1]
    v_pk_fma_f32 v[28:29], v[154:155], v[56:57], v[28:29] op_sel:[0,1,0] op_sel_hi:[1,1,1]
    v_pk_fma_f32 v[30:31], v[156:157], v[56:57], v[30:31] op_sel:[0,1,0] op_sel_hi:[1,1,1]
    v_pk_fma_f32 v[32:33], v[158:159], v[56:57], v[32:33] op_sel:[0,1,0] op_sel_hi:[1,1,1]
    v_pk_fma_f32 v[34:35], v[160:161], v[56:57], v[34:35] op_sel:[0,1,0] op_sel_hi:[1,1,1]
    v_pk_fma_f32 v[36:37], v[162:163], v[56:57], v[36:37] op_sel:[0,1,0] op_sel_hi:[1,1,1]
    v_pk_fma_f32 v[38:39], v[164:165], v[56:57], v[38:39] op_sel:[0,1,0] op_sel_hi:[1,1,1]
    v_pk_fma_f32 v[40:41], v[166:167], v[56:57], v[40:41] op_sel:[0,1,0] op_sel_hi:[1,1,1]
    ds_read_b128 v[128:131], v79 offset:352
    ds_read_b128 v[132:135], v79 offset:368
    ds_read_b128 v[136:139], v79 offset:384
PD_Q3_0_6:
    s_cbranch_execz PD_Q3_0_7
    ds_read_b128 v[140:143], v79 offset:400
    ds_read_b128 v[144:147], v79 offset:416
    ds_read_b128 v[148:151], v79 offset:432
    ds_read_b128 v[152:155], v79 offset:448
    ds_read_b128 v[156:159], v79 offset:464
    ds_read_b128 v[160:163], v79 offset:480
    ds_read_b128 v[164:167], v79 offset:496
    s_waitcnt lgkmcnt(0)
    v_pk_fma_f32 v[2:3], v[128:129], v[50:51], v[2:3] op_sel:[0,1,0] op_sel_hi:[1,1,1]
    v_pk_fma_f32 v[4:5], v[130:131], v[50:51], v[4:5] op_sel:[0,1,0] op_sel_hi:[1,1,1]
    v_pk_fma_f32 v[6:7], v[132:133], v[50:51], v[6:7] op_sel:[0,1,0] op_sel_hi:[1,1,1]
    v_pk_fma_f32 v[8:9], v[134:135], v[50:51], v[8:9] op_sel:[0,1,0] op_sel_hi:[1,1,1]
    v_pk_fma_f32 v[10:11], v[136:137], v[50:51], v[10:11] op_sel:[0,1,0] op_sel_hi:[1,1,1]
    v_pk_fma_f32 v[12:13], v[138:139], v[50:51], v[12:13] op_sel:[0,1,0] op_sel_hi:[1,1,1]
    v_pk_fma_f32 v[14:15], v[140:141], v[50:51], v[14:15] op_sel:[0,1,0] op_sel_hi:[1,1,1]
    v_pk_fma_f32 v[16:17], v[142:143], v[50:51], v[16:17] op_sel:[0,1,0] op_sel_hi:[1,1,1]
PD_Q3_0_7:
    s_cbranch_execz PD_Q3_0_8
    v_pk_fma_f32 v[18:19], v[144:145], v[50:51], v[18:19] op_sel:[0,1,0] op_sel_hi:[1,1,1]
    v_pk_fma_f32 v[20:21], v[146:147], v[50:51], v[20:21] op_sel:[0,1,0] op_sel_hi:[1,1,1]
    v_pk_fma_f32 v[22:23], v[148:149], v[58:59], v[22:23] op_sel:[0,1,0] op_sel_hi:[1,1,1]
    v_pk_fma_f32 v[24:25], v[150:151], v[58:59], v[24:25] op_sel:[0,1,0] op_sel_hi:[1,1,1]
    v_pk_fma_f32 v[26:27], v[152:153], v[58:59], v[26:27] op_sel:[0,1,0] op_sel_hi:[1,1,1]
    v_pk_fma_f32 v[28:29], v[154:155], v[58:59], v[28:29] op_sel:[0,1,0] op_sel_hi:[1,1,1]
    v_pk_fma_f32 v[30:31], v[156:157], v[58:59], v[30:31] op_sel:[0,1,0] op_sel_hi:[1,1,1]
    v_pk_fma_f32 v[32:33], v[158:159], v[58:59], v[32:33] op_sel:[0,1,0] op_sel_hi:[1,1,1]
    v_pk_fma_f32 v[34:35], v[160:161], v[58:59], v[34:35] op_sel:[0,1,0] op_sel_hi:[1,1,1]
    v_pk_fma_f32 v[36:37], v[162:163], v[58:59], v[36:37] op_sel:[0,1,0] op_sel_hi:[1,1,1]
    v_pk_fma_f32 v[38:39], v[164:165], v[58:59], v[38:39] op_sel:[0,1,0] op_sel_hi:[1,1,1]
    v_pk_fma_f32 v[40:41], v[166:167], v[58:59], v[40:41] op_sel:[0,1,0] op_sel_hi:[1,1,1]
    v_cvt_pk_bf16_f32 v44, v2, v3
    v_cvt_pk_bf16_f32 v45, v4, v5
    v_cvt_pk_bf16_f32 v46, v6, v7
    v_cvt_pk_bf16_f32 v47, v8, v9
PD_Q3_0_8:
    s_cbranch_execz PD_Q3_0_9
    v_cvt_pk_bf16_f32 v48, v10, v11
    v_cvt_pk_bf16_f32 v49, v12, v13
    v_cvt_pk_bf16_f32 v50, v14, v15
    v_cvt_pk_bf16_f32 v51, v16, v17
    v_cvt_pk_bf16_f32 v52, v18, v19
    v_cvt_pk_bf16_f32 v53, v20, v21
    v_cvt_pk_bf16_f32 v54, v22, v23
    v_cvt_pk_bf16_f32 v55, v24, v25
    v_cvt_pk_bf16_f32 v56, v26, v27
    v_cvt_pk_bf16_f32 v57, v28, v29
    v_cvt_pk_bf16_f32 v58, v30, v31
    v_cvt_pk_bf16_f32 v59, v32, v33
    v_cvt_pk_bf16_f32 v60, v34, v35
    v_cvt_pk_bf16_f32 v61, v36, v37
    v_cvt_pk_bf16_f32 v62, v38, v39
PD_Q3_0_9:
    s_cbranch_execz CH_T
    v_cvt_pk_bf16_f32 v63, v40, v41
    v_lshlrev_b32 v3, 4, v76
    v_mul_u32_u24 v4, 10240, v77
    v_add_u32 v3, v3, v4
    s_mul_i32 s47, s39, 8
    s_add_u32 s47, s47, s40
    s_mul_i32 s47, s47, 20480
    s_add_u32 s47, s47, 14680064
    s_add_u32 s48, s47, 4096
    s_add_u32 s49, s47, 8192
    buffer_store_dwordx4 v[44:47], v3, s[12:15], s47 offen offset:0 sc1
    buffer_store_dwordx4 v[48:51], v3, s[12:15], s47 offen offset:2048 sc1
    buffer_store_dwordx4 v[52:55], v3, s[12:15], s48 offen offset:0 sc1
    buffer_store_dwordx4 v[56:59], v3, s[12:15], s48 offen offset:2048 sc1
    buffer_store_dwordx4 v[60:63], v3, s[12:15], s49 offen offset:0 sc1
L1_fin:
    s_nop 0
    s_lshl_b32 s47, s56, 6
    s_lshl_b32 s48, s36, 4
    s_add_u32 s47, s47, s48
    v_and_b32 v10, 15, v1
    s_nop 0
    v_add_u32 v10, s47, v10
    v_mul_u32_u24 v10, 1280, v10
    v_lshrrev_b32 v11, 4, v1
    v_lshlrev_b32 v11, 3, v11
    s_mul_i32 s47, s57, 160
    v_add_u32 v11, s47, v11
    v_add_u32 v10, v10, v11
    v_lshlrev_b32 v2, 4, v1
    v_mov_b32 v3, v125
    v_mov_b32 v4, v126
    s_mul_i32 s47, s56, 303104
    v_add_u32 v124, s47, v2
    s_lshl_b32 s47, s56, 6
    s_max_u32 s48, s47, 14
    s_sub_u32 s48, s48, 14
    s_mul_i32 s48, s48, 4600
    s_lshr_b32 s48, s48, 19
    s_add_u32 s47, s47, 49
    s_mul_i32 s47, s47, 4600
    s_lshr_b32 s47, s47, 19
    s_lshr_b32 s49, s56, 1
    s_add_u32 s49, s49, 18
    v_mov_b32 v5, s48
    v_mov_b32 v6, s47
    v_cmp_lt_u32 vcc, 7, v1
    s_nop 1
    s_nop 0
    v_cndmask_b32 v5, v5, v6, vcc
    v_mov_b32 v6, s49
    v_cmp_lt_u32 vcc, 15, v1
    s_nop 1
    v_cndmask_b32 v5, v5, v6, vcc
    v_min_u32 v6, 22, v1
    v_and_b32 v6, 7, v6
    v_lshl_add_u32 v5, v5, 3, v6
    v_lshlrev_b32 v5, 7, v5

    v_cmp_eq_u32 vcc, 0, v0
    v_mov_b32 v6, 1073741824
    s_lshl_b32 s48, s39, 3
    s_add_u32 s48, s48, s40
    s_cmp_eq_u32 s42, 1
    s_cselect_b32 s49, 0, 144
    s_add_u32 s48, s48, s49
    s_lshl_b32 s48, s48, 7
    v_mov_b32 v7, s48
    v_cndmask_b32 v6, v6, v7, vcc
    v_mov_b32 v7, s79
    s_mov_b32 s48, 14024704
    s_mov_b32 s28, s72
    s_mov_b32 s29, s73
    s_mov_b32 s30, 2621440
    s_mov_b32 s31, 0x20000
    s_waitcnt vmcnt(0)
    s_nop 0
    s_barrier
    buffer_store_dword v7, v6, s[12:15], s48 offen sc1
    v_add_u32 v20, s69, v2
    v_lshrrev_b32 v21, 1, v2
    v_add_u32 v21, s69, v21
    ds_write_b128 v20, a[100:103]
    ds_write_b128 v20, a[104:107] offset:1024
    ds_write_b64 v21, a[108:109] offset:2048
    v_and_b32 v22, 15, v1
    v_mul_u32_u24 v22, 160, v22
    v_lshrrev_b32 v23, 4, v1
    v_lshl_add_u32 v22, v23, 3, v22
    v_add_u32 v22, s69, v22
    ds_read_b64 v[208:209], v22 offset:0
    ds_read_b64 v[210:211], v22 offset:32
    ds_read_b64 v[212:213], v22 offset:64
    ds_read_b64 v[214:215], v22 offset:96
    ds_read_b64 v[216:217], v22 offset:128
    s_lshl_b32 s47, s56, 6
    v_and_b32 v12, 15, v1
    s_nop 0
    v_add_u32 v12, s47, v12
    v_lshrrev_b32 v13, 4, v1
    s_mul_i32 s47, s36, 20
    v_add_u32 v13, s47, v13
    v_lshlrev_b32 v13, 11, v13
    v_add_u32 v13, 14680064, v13
    s_nop 2
    s_add_u32 s47, s36, 0
    s_and_b32 s47, s47, 3
    s_lshl_b32 s47, s47, 4
    v_add_u32 v14, s47, v12
    v_subrev_u32 v15, 14, v14
    v_max_i32 v15, 0, v15
    v_mul_u32_u24 v15, 4600, v15
    v_lshrrev_b32 v15, 19, v15
    v_mul_u32_u24 v6, 10126, v15
    v_add_u32 v6, v6, v14
    v_lshl_add_u32 v6, v6, 4, v13
    s_add_u32 s47, s36, 1
    s_and_b32 s47, s47, 3
    s_lshl_b32 s47, s47, 4
    v_add_u32 v14, s47, v12
    v_subrev_u32 v15, 14, v14
    v_max_i32 v15, 0, v15
    v_mul_u32_u24 v15, 4600, v15
    v_lshrrev_b32 v15, 19, v15
    s_nop 0
    v_mul_u32_u24 v7, 10126, v15
    v_add_u32 v7, v7, v14
    v_lshl_add_u32 v7, v7, 4, v13
    s_add_u32 s47, s36, 2
    s_and_b32 s47, s47, 3
    s_lshl_b32 s47, s47, 4
    v_add_u32 v14, s47, v12
    v_subrev_u32 v15, 14, v14
    v_max_i32 v15, 0, v15
    v_mul_u32_u24 v15, 4600, v15
    v_lshrrev_b32 v15, 19, v15
    v_mul_u32_u24 v8, 10126, v15
    v_add_u32 v8, v8, v14
    v_lshl_add_u32 v8, v8, 4, v13
    s_add_u32 s47, s36, 3
    s_and_b32 s47, s47, 3
    s_lshl_b32 s47, s47, 4
    v_add_u32 v14, s47, v12
    v_subrev_u32 v15, 14, v14
    v_max_i32 v15, 0, v15
    v_mul_u32_u24 v15, 4600, v15
    v_lshrrev_b32 v15, 19, v15
    v_mul_u32_u24 v9, 10126, v15
    v_add_u32 v9, v9, v14
    s_nop 0
    v_lshl_add_u32 v9, v9, 4, v13
    s_add_u32 s47, s36, 0
    s_and_b32 s47, s47, 3
    s_mul_i32 s47, s47, 75776
    v_add_u32 v12, s47, v124
    s_add_u32 s47, s36, 1
    s_and_b32 s47, s47, 3
    s_mul_i32 s47, s47, 75776
    v_add_u32 v13, s47, v124
    s_add_u32 s47, s36, 2
    s_and_b32 s47, s47, 3
    s_mul_i32 s47, s47, 75776
    v_add_u32 v14, s47, v124
    s_add_u32 s47, s36, 3
    s_and_b32 s47, s47, 3
    s_mul_i32 s47, s47, 75776
    v_add_u32 v15, s47, v124
    s_cmp_eq_u32 s42, 1
    s_cbranch_scc1 L2_lskip
    s_add_u32 s65, s63, 7
    s_mul_i32 s65, s65, 5120
    s_add_u32 m0, s68, 0
    s_nop 0
    buffer_load_dwordx4 v3, s[12:15], s65 offen offset:0 sc1 lds
    s_nop 0
    buffer_load_dwordx4 v3, s[12:15], s65 offen offset:1024 sc1 lds
    buffer_load_dwordx4 v3, s[12:15], s65 offen offset:2048 sc1 lds
    buffer_load_dwordx4 v3, s[12:15], s65 offen offset:3072 sc1 lds
    s_add_u32 m0, s68, 4096
    s_nop 0
    buffer_load_dwordx4 v4, s[12:15], s65 offen sc1 lds
    s_add_u32 s65, s63, 8
    s_mul_i32 s65, s65, 5120
    s_add_u32 m0, s68, 5120
    s_nop 0
    buffer_load_dwordx4 v3, s[12:15], s65 offen offset:0 sc1 lds
    buffer_load_dwordx4 v3, s[12:15], s65 offen offset:1024 sc1 lds
    buffer_load_dwordx4 v3, s[12:15], s65 offen offset:2048 sc1 lds
    buffer_load_dwordx4 v3, s[12:15], s65 offen offset:3072 sc1 lds
    s_add_u32 m0, s68, 9216
    s_nop 0
    buffer_load_dwordx4 v4, s[12:15], s65 offen sc1 lds
    s_add_u32 s65, s63, 9
    s_nop 0
    s_mul_i32 s65, s65, 5120
    s_add_u32 m0, s68, 122880
    s_nop 0
    buffer_load_dwordx4 v3, s[12:15], s65 offen offset:0 sc1 lds
    buffer_load_dwordx4 v3, s[12:15], s65 offen offset:1024 sc1 lds
    buffer_load_dwordx4 v3, s[12:15], s65 offen offset:2048 sc1 lds
    buffer_load_dwordx4 v3, s[12:15], s65 offen offset:3072 sc1 lds
    s_add_u32 m0, s68, 126976
    s_nop 0
    buffer_load_dwordx4 v4, s[12:15], s65 offen sc1 lds
L2_lskip:
    s_add_u32 s65, s63, 10
    s_mul_i32 s65, s65, 5120
    s_add_u32 m0, s68, 128000
    s_nop 0
    buffer_load_dwordx4 v3, s[12:15], s65 offen offset:0 sc1 lds
    buffer_load_dwordx4 v3, s[12:15], s65 offen offset:1024 sc1 lds
    buffer_load_dwordx4 v3, s[12:15], s65 offen offset:2048 sc1 lds
    buffer_load_dwordx4 v3, s[12:15], s65 offen offset:3072 sc1 lds
    s_nop 0
    s_add_u32 m0, s68, 132096
    s_nop 0
    buffer_load_dwordx4 v4, s[12:15], s65 offen sc1 lds
    s_cmp_eq_u32 s36, 0
    s_cbranch_scc0 L2_p_done
    s_mov_b32 s50, 14024704
    buffer_load_dword v16, v5, s[12:15], s50 offen sc1
    s_mov_b32 s49, 0
L2_spin:
    buffer_load_dword v17, v5, s[12:15], s50 offen sc1
    s_waitcnt vmcnt(1)
    v_cmp_ne_u32 vcc, s79, v16
    s_cbranch_vccz L2_p_done
    buffer_load_dword v16, v5, s[12:15], s50 offen sc1
    s_waitcnt vmcnt(1)
    v_cmp_ne_u32 vcc, s79, v17
    s_cbranch_vccz L2_p_done
    s_add_u32 s49, s49, 1
    s_cmp_gt_u32 s49, 20000
    s_cbranch_scc0 L2_spin
L2_p_done:
    s_waitcnt vmcnt(0)
L2_p_ok:
    s_barrier
R_S:
    v_mov_b32 v0, v3
    v_mov_b32 v1, v4
    v_add_u32 v3, s68, v2
    v_add_u32 v5, s69, v2
    v_add_u32 v4, 122880, v3
    s_mov_b32 s48, 0
    buffer_load_dwordx4 v[16:19], v6, s[12:15], s48 offen sc1
    buffer_load_dwordx4 v[20:23], v7, s[12:15], s48 offen sc1
    buffer_load_dwordx4 v[24:27], v8, s[12:15], s48 offen sc1
    buffer_load_dwordx4 v[28:31], v9, s[12:15], s48 offen sc1
    s_mov_b32 s48, 8192
    buffer_load_dwordx4 v[32:35], v6, s[12:15], s48 offen sc1
    buffer_load_dwordx4 v[36:39], v7, s[12:15], s48 offen sc1
    buffer_load_dwordx4 v[40:43], v8, s[12:15], s48 offen sc1
    buffer_load_dwordx4 v[44:47], v9, s[12:15], s48 offen sc1
    s_mov_b32 s48, 16384
    buffer_load_dwordx4 v[48:51], v6, s[12:15], s48 offen sc1
    buffer_load_dwordx4 v[52:55], v7, s[12:15], s48 offen sc1
    buffer_load_dwordx4 v[56:59], v8, s[12:15], s48 offen sc1
    buffer_load_dwordx4 v[60:63], v9, s[12:15], s48 offen sc1
    v_accvgpr_read_b32 v218, a110
    s_waitcnt lgkmcnt(0)
    s_nop 0
    v_mov_b32_dpp v229, v218 row_newbcast:0 row_mask:0xf bank_mask:0xf
    v_lshlrev_b32 v128, 16, v208
    v_and_b32 v129, 0xffff0000, v208
    v_lshlrev_b32 v228, 16, v229
    v_and_b32 v229, 0xffff0000, v229
    v_pk_add_f32 v[128:129], v[128:129], v[228:229]
    s_nop 0
    v_mov_b32_dpp v229, v218 row_newbcast:1 row_mask:0xf bank_mask:0xf
    v_lshlrev_b32 v130, 16, v209
    v_and_b32 v131, 0xffff0000, v209
    v_lshlrev_b32 v228, 16, v229
    v_and_b32 v229, 0xffff0000, v229
    v_pk_add_f32 v[130:131], v[130:131], v[228:229]
    s_nop 0
    v_mov_b32_dpp v229, v218 row_newbcast:2 row_mask:0xf bank_mask:0xf
    v_lshlrev_b32 v132, 16, v210
    v_and_b32 v133, 0xffff0000, v210
    v_lshlrev_b32 v228, 16, v229
    v_and_b32 v229, 0xffff0000, v229
    v_pk_add_f32 v[132:133], v[132:133], v[228:229]
    s_nop 0
    v_mov_b32_dpp v229, v218 row_newbcast:3 row_mask:0xf bank_mask:0xf
    v_lshlrev_b32 v134, 16, v211
    v_and_b32 v135, 0xffff0000, v211
    v_lshlrev_b32 v228, 16, v229
    v_and_b32 v229, 0xffff0000, v229
    v_pk_add_f32 v[134:135], v[134:135], v[228:229]
    s_nop 0
    v_mov_b32_dpp v229, v218 row_newbcast:4 row_mask:0xf bank_mask:0xf
    v_lshlrev_b32 v136, 16, v212
    v_and_b32 v137, 0xffff0000, v212
    v_lshlrev_b32 v228, 16, v229
    v_and_b32 v229, 0xffff0000, v229
    v_pk_add_f32 v[136:137], v[136:137], v[228:229]
    s_nop 0
    v_mov_b32_dpp v229, v218 row_newbcast:5 row_mask:0xf bank_mask:0xf
    v_lshlrev_b32 v138, 16, v213
    v_and_b32 v139, 0xffff0000, v213
    v_lshlrev_b32 v228, 16, v229
    v_and_b32 v229, 0xffff0000, v229
    v_pk_add_f32 v[138:139], v[138:139], v[228:229]
    s_nop 0
    v_mov_b32_dpp v229, v218 row_newbcast:6 row_mask:0xf bank_mask:0xf
    v_lshlrev_b32 v140, 16, v214
    v_and_b32 v141, 0xffff0000, v214
    v_lshlrev_b32 v228, 16, v229
    v_and_b32 v229, 0xffff0000, v229
    v_pk_add_f32 v[140:141], v[140:141], v[228:229]
    s_nop 0
    v_mov_b32_dpp v229, v218 row_newbcast:7 row_mask:0xf bank_mask:0xf
    v_lshlrev_b32 v142, 16, v215
    v_and_b32 v143, 0xffff0000, v215
    v_lshlrev_b32 v228, 16, v229
    v_and_b32 v229, 0xffff0000, v229
    v_pk_add_f32 v[142:143], v[142:143], v[228:229]
    s_nop 0
    v_mov_b32_dpp v229, v218 row_newbcast:8 row_mask:0xf bank_mask:0xf
    v_lshlrev_b32 v144, 16, v216
    v_and_b32 v145, 0xffff0000, v216
    v_lshlrev_b32 v228, 16, v229
    v_and_b32 v229, 0xffff0000, v229
    v_pk_add_f32 v[144:145], v[144:145], v[228:229]
    s_nop 0
    v_mov_b32_dpp v229, v218 row_newbcast:9 row_mask:0xf bank_mask:0xf
    v_lshlrev_b32 v146, 16, v217
    v_and_b32 v147, 0xffff0000, v217
    v_lshlrev_b32 v228, 16, v229
    v_and_b32 v229, 0xffff0000, v229
    v_pk_add_f32 v[146:147], v[146:147], v[228:229]
    s_mov_b64 exec, 0
    s_cmp_eq_u32 s36, 0
    s_cbranch_scc1 CH_S0
    s_cmp_eq_u32 s36, 1
    s_cbranch_scc1 CH_S1
    s_cmp_eq_u32 s36, 2
    s_cbranch_scc1 CH_S2
    s_branch CH_S3
Lwarm2_ret:
    s_mov_b64 exec, -1
    s_waitcnt vmcnt(8)
    v_mfma_f32_16x16x32_bf16 v[128:131], a[112:115], v[16:19], v[128:131]
    s_mov_b32 s48, 24576
    buffer_load_dwordx4 v[64:67], v6, s[12:15], s48 offen sc1
    v_mfma_f32_16x16x32_bf16 v[132:135], a[116:119], v[16:19], v[132:135]
    v_mfma_f32_16x16x32_bf16 v[136:139], a[120:123], v[16:19], v[136:139]
    v_mfma_f32_16x16x32_bf16 v[140:143], a[124:127], v[16:19], v[140:143]
    v_mfma_f32_16x16x32_bf16 v[144:147], a[128:131], v[16:19], v[144:147]
    buffer_load_dwordx4 v[68:71], v7, s[12:15], s48 offen sc1
    v_mfma_f32_16x16x32_bf16 v[148:151], a[112:115], v[20:23], 0
    v_mfma_f32_16x16x32_bf16 v[152:155], a[116:119], v[20:23], 0
    v_mfma_f32_16x16x32_bf16 v[156:159], a[120:123], v[20:23], 0
    v_mfma_f32_16x16x32_bf16 v[160:163], a[124:127], v[20:23], 0
    buffer_load_dwordx4 v[72:75], v8, s[12:15], s48 offen sc1
    v_mfma_f32_16x16x32_bf16 v[164:167], a[128:131], v[20:23], 0
    v_mfma_f32_16x16x32_bf16 v[168:171], a[112:115], v[24:27], 0
    v_mfma_f32_16x16x32_bf16 v[172:175], a[116:119], v[24:27], 0
    v_mfma_f32_16x16x32_bf16 v[176:179], a[120:123], v[24:27], 0
    buffer_load_dwordx4 v[76:79], v9, s[12:15], s48 offen sc1
    v_mfma_f32_16x16x32_bf16 v[180:183], a[124:127], v[24:27], 0
    v_mfma_f32_16x16x32_bf16 v[184:187], a[128:131], v[24:27], 0
    v_mfma_f32_16x16x32_bf16 v[188:191], a[112:115], v[28:31], 0
    v_mfma_f32_16x16x32_bf16 v[192:195], a[116:119], v[28:31], 0
    s_mov_b32 s48, 32768
    buffer_load_dwordx4 v[80:83], v6, s[12:15], s48 offen sc1
    v_mfma_f32_16x16x32_bf16 v[196:199], a[120:123], v[28:31], 0
    v_mfma_f32_16x16x32_bf16 v[200:203], a[124:127], v[28:31], 0
    v_mfma_f32_16x16x32_bf16 v[204:207], a[128:131], v[28:31], 0
    s_waitcnt vmcnt(9)
    v_mfma_f32_16x16x32_bf16 v[128:131], a[132:135], v[32:35], v[128:131]
    buffer_load_dwordx4 v[84:87], v7, s[12:15], s48 offen sc1
    v_mfma_f32_16x16x32_bf16 v[132:135], a[136:139], v[32:35], v[132:135]
    v_mfma_f32_16x16x32_bf16 v[136:139], a[140:143], v[32:35], v[136:139]
    ds_read_b128 a[112:115], v3 offset:0
    v_mfma_f32_16x16x32_bf16 v[140:143], a[144:147], v[32:35], v[140:143]
    v_mfma_f32_16x16x32_bf16 v[144:147], a[148:151], v[32:35], v[144:147]
    buffer_load_dwordx4 v[88:91], v8, s[12:15], s48 offen sc1
    v_mfma_f32_16x16x32_bf16 v[148:151], a[132:135], v[36:39], v[148:151]
    v_mfma_f32_16x16x32_bf16 v[152:155], a[136:139], v[36:39], v[152:155]
    ds_read_b128 a[116:119], v3 offset:1024
    v_mfma_f32_16x16x32_bf16 v[156:159], a[140:143], v[36:39], v[156:159]
    v_mfma_f32_16x16x32_bf16 v[160:163], a[144:147], v[36:39], v[160:163]
    buffer_load_dwordx4 v[92:95], v9, s[12:15], s48 offen sc1
    v_mfma_f32_16x16x32_bf16 v[164:167], a[148:151], v[36:39], v[164:167]
    v_mfma_f32_16x16x32_bf16 v[168:171], a[132:135], v[40:43], v[168:171]
    ds_read_b128 a[120:123], v3 offset:2048
    v_mfma_f32_16x16x32_bf16 v[172:175], a[136:139], v[40:43], v[172:175]
    v_mfma_f32_16x16x32_bf16 v[176:179], a[140:143], v[40:43], v[176:179]
    s_lshl_b32 s48, s63, 10
    buffer_load_dwordx4 v[96:99], v12, s[12:15], s48 offen offset:0 sc1
    v_mfma_f32_16x16x32_bf16 v[180:183], a[144:147], v[40:43], v[180:183]
    v_mfma_f32_16x16x32_bf16 v[184:187], a[148:151], v[40:43], v[184:187]
    ds_read_b128 a[124:127], v3 offset:3072
    v_mfma_f32_16x16x32_bf16 v[188:191], a[132:135], v[44:47], v[188:191]
    v_mfma_f32_16x16x32_bf16 v[192:195], a[136:139], v[44:47], v[192:195]
    buffer_load_dwordx4 v[100:103], v13, s[12:15], s48 offen offset:0 sc1
    v_mfma_f32_16x16x32_bf16 v[196:199], a[140:143], v[44:47], v[196:199]
    v_mfma_f32_16x16x32_bf16 v[200:203], a[144:147], v[44:47], v[200:203]
    ds_read_b128 a[128:131], v3 offset:4096
    v_mfma_f32_16x16x32_bf16 v[204:207], a[148:151], v[44:47], v[204:207]
    s_waitcnt vmcnt(10)
    v_mfma_f32_16x16x32_bf16 v[128:131], a[152:155], v[48:51], v[128:131]
    buffer_load_dwordx4 v[104:107], v14, s[12:15], s48 offen offset:0 sc1
    v_mfma_f32_16x16x32_bf16 v[132:135], a[156:159], v[48:51], v[132:135]
    v_mfma_f32_16x16x32_bf16 v[136:139], a[160:163], v[48:51], v[136:139]
    ds_read_b128 a[132:135], v3 offset:5120
    v_mfma_f32_16x16x32_bf16 v[140:143], a[164:167], v[48:51], v[140:143]
    v_mfma_f32_16x16x32_bf16 v[144:147], a[168:171], v[48:51], v[144:147]
    buffer_load_dwordx4 v[108:111], v15, s[12:15], s48 offen offset:0 sc1
    v_mfma_f32_16x16x32_bf16 v[148:151], a[152:155], v[52:55], v[148:151]
    v_mfma_f32_16x16x32_bf16 v[152:155], a[156:159], v[52:55], v[152:155]
    ds_read_b128 a[136:139], v3 offset:6144
    v_mfma_f32_16x16x32_bf16 v[156:159], a[160:163], v[52:55], v[156:159]
    v_mfma_f32_16x16x32_bf16 v[160:163], a[164:167], v[52:55], v[160:163]
    buffer_load_dwordx4 v[112:115], v12, s[12:15], s48 offen offset:1024 sc1
    v_mfma_f32_16x16x32_bf16 v[164:167], a[168:171], v[52:55], v[164:167]
    v_mfma_f32_16x16x32_bf16 v[168:171], a[152:155], v[56:59], v[168:171]
    ds_read_b128 a[140:143], v3 offset:7168
    v_mfma_f32_16x16x32_bf16 v[172:175], a[156:159], v[56:59], v[172:175]
    v_mfma_f32_16x16x32_bf16 v[176:179], a[160:163], v[56:59], v[176:179]
    buffer_load_dwordx4 v[116:119], v13, s[12:15], s48 offen offset:1024 sc1
    v_mfma_f32_16x16x32_bf16 v[180:183], a[164:167], v[56:59], v[180:183]
    v_mfma_f32_16x16x32_bf16 v[184:187], a[168:171], v[56:59], v[184:187]
    ds_read_b128 a[144:147], v3 offset:8192
    v_mfma_f32_16x16x32_bf16 v[188:191], a[152:155], v[60:63], v[188:191]
    v_mfma_f32_16x16x32_bf16 v[192:195], a[156:159], v[60:63], v[192:195]
    buffer_load_dwordx4 v[120:123], v14, s[12:15], s48 offen offset:1024 sc1
    v_mfma_f32_16x16x32_bf16 v[196:199], a[160:163], v[60:63], v[196:199]
    v_mfma_f32_16x16x32_bf16 v[200:203], a[164:167], v[60:63], v[200:203]
    ds_read_b128 a[148:151], v3 offset:9216
    v_mfma_f32_16x16x32_bf16 v[204:207], a[168:171], v[60:63], v[204:207]
    s_waitcnt vmcnt(11)
    v_mfma_f32_16x16x32_bf16 v[128:131], a[172:175], v[64:67], v[128:131]
    buffer_load_dwordx4 v[124:127], v15, s[12:15], s48 offen offset:1024 sc1
    v_mfma_f32_16x16x32_bf16 v[132:135], a[176:179], v[64:67], v[132:135]
    v_mfma_f32_16x16x32_bf16 v[136:139], a[180:183], v[64:67], v[136:139]
    ds_read_b128 a[152:155], v4 offset:0
    v_mfma_f32_16x16x32_bf16 v[140:143], a[184:187], v[64:67], v[140:143]
    v_mfma_f32_16x16x32_bf16 v[144:147], a[188:191], v[64:67], v[144:147]
    buffer_load_dwordx4 v[208:211], v12, s[12:15], s48 offen offset:2048 sc1
    v_mfma_f32_16x16x32_bf16 v[148:151], a[172:175], v[68:71], v[148:151]
    v_mfma_f32_16x16x32_bf16 v[152:155], a[176:179], v[68:71], v[152:155]
    ds_read_b128 a[156:159], v4 offset:1024
    v_mfma_f32_16x16x32_bf16 v[156:159], a[180:183], v[68:71], v[156:159]
    v_mfma_f32_16x16x32_bf16 v[160:163], a[184:187], v[68:71], v[160:163]
    buffer_load_dwordx4 v[212:215], v13, s[12:15], s48 offen offset:2048 sc1
    v_mfma_f32_16x16x32_bf16 v[164:167], a[188:191], v[68:71], v[164:167]
    v_mfma_f32_16x16x32_bf16 v[168:171], a[172:175], v[72:75], v[168:171]
    ds_read_b128 a[160:163], v4 offset:2048
    v_mfma_f32_16x16x32_bf16 v[172:175], a[176:179], v[72:75], v[172:175]
    v_mfma_f32_16x16x32_bf16 v[176:179], a[180:183], v[72:75], v[176:179]
    buffer_load_dwordx4 v[216:219], v14, s[12:15], s48 offen offset:2048 sc1
    v_mfma_f32_16x16x32_bf16 v[180:183], a[184:187], v[72:75], v[180:183]
    v_mfma_f32_16x16x32_bf16 v[184:187], a[188:191], v[72:75], v[184:187]
    ds_read_b128 a[164:167], v4 offset:3072
    v_mfma_f32_16x16x32_bf16 v[188:191], a[172:175], v[76:79], v[188:191]
    v_mfma_f32_16x16x32_bf16 v[192:195], a[176:179], v[76:79], v[192:195]
    buffer_load_dwordx4 v[220:223], v15, s[12:15], s48 offen offset:2048 sc1
    v_mfma_f32_16x16x32_bf16 v[196:199], a[180:183], v[76:79], v[196:199]
    v_mfma_f32_16x16x32_bf16 v[200:203], a[184:187], v[76:79], v[200:203]
    ds_read_b128 a[168:171], v4 offset:4096
    v_mfma_f32_16x16x32_bf16 v[204:207], a[188:191], v[76:79], v[204:207]
    s_waitcnt vmcnt(12)
    v_mfma_f32_16x16x32_bf16 v[128:131], a[192:195], v[80:83], v[128:131]
    buffer_load_dwordx4 v[224:227], v12, s[12:15], s48 offen offset:3072 sc1
    v_mfma_f32_16x16x32_bf16 v[132:135], a[196:199], v[80:83], v[132:135]
    v_mfma_f32_16x16x32_bf16 v[136:139], a[200:203], v[80:83], v[136:139]
    ds_read_b128 a[172:175], v4 offset:5120
    v_mfma_f32_16x16x32_bf16 v[140:143], a[204:207], v[80:83], v[140:143]
    v_mfma_f32_16x16x32_bf16 v[144:147], a[208:211], v[80:83], v[144:147]
    buffer_load_dwordx4 v[228:231], v13, s[12:15], s48 offen offset:3072 sc1
    v_mfma_f32_16x16x32_bf16 v[148:151], a[192:195], v[84:87], v[148:151]
    v_mfma_f32_16x16x32_bf16 v[152:155], a[196:199], v[84:87], v[152:155]
    ds_read_b128 a[176:179], v4 offset:6144
    v_mfma_f32_16x16x32_bf16 v[156:159], a[200:203], v[84:87], v[156:159]
    v_mfma_f32_16x16x32_bf16 v[160:163], a[204:207], v[84:87], v[160:163]
    buffer_load_dwordx4 v[232:235], v14, s[12:15], s48 offen offset:3072 sc1
    v_mfma_f32_16x16x32_bf16 v[164:167], a[208:211], v[84:87], v[164:167]
    v_mfma_f32_16x16x32_bf16 v[168:171], a[192:195], v[88:91], v[168:171]
    ds_read_b128 a[180:183], v4 offset:7168
    v_mfma_f32_16x16x32_bf16 v[172:175], a[196:199], v[88:91], v[172:175]
    v_mfma_f32_16x16x32_bf16 v[176:179], a[200:203], v[88:91], v[176:179]
    buffer_load_dwordx4 v[236:239], v15, s[12:15], s48 offen offset:3072 sc1
    v_mfma_f32_16x16x32_bf16 v[180:183], a[204:207], v[88:91], v[180:183]
    v_mfma_f32_16x16x32_bf16 v[184:187], a[208:211], v[88:91], v[184:187]
    ds_read_b128 a[184:187], v4 offset:8192
    v_mfma_f32_16x16x32_bf16 v[188:191], a[192:195], v[92:95], v[188:191]
    v_mfma_f32_16x16x32_bf16 v[192:195], a[196:199], v[92:95], v[192:195]
    s_add_u32 s48, s48, 4096
    buffer_load_dwordx4 v[240:243], v12, s[12:15], s48 offen offset:0 sc1
    v_mfma_f32_16x16x32_bf16 v[196:199], a[200:203], v[92:95], v[196:199]
    v_mfma_f32_16x16x32_bf16 v[200:203], a[204:207], v[92:95], v[200:203]
    ds_read_b128 a[188:191], v4 offset:9216
    v_mfma_f32_16x16x32_bf16 v[204:207], a[208:211], v[92:95], v[204:207]
    s_waitcnt vmcnt(13)
    v_mfma_f32_16x16x32_bf16 v[128:131], a[212:215], v[96:99], v[128:131]
    buffer_load_dwordx4 v[244:247], v13, s[12:15], s48 offen offset:0 sc1
    v_mfma_f32_16x16x32_bf16 v[132:135], a[216:219], v[96:99], v[132:135]
    v_mfma_f32_16x16x32_bf16 v[136:139], a[220:223], v[96:99], v[136:139]
    v_mfma_f32_16x16x32_bf16 v[140:143], a[224:227], v[96:99], v[140:143]
    v_mfma_f32_16x16x32_bf16 v[144:147], a[228:231], v[96:99], v[144:147]
    buffer_load_dwordx4 v[248:251], v14, s[12:15], s48 offen offset:0 sc1
    v_mfma_f32_16x16x32_bf16 v[148:151], a[212:215], v[100:103], v[148:151]
    v_mfma_f32_16x16x32_bf16 v[152:155], a[216:219], v[100:103], v[152:155]
    v_mfma_f32_16x16x32_bf16 v[156:159], a[220:223], v[100:103], v[156:159]
    v_mfma_f32_16x16x32_bf16 v[160:163], a[224:227], v[100:103], v[160:163]
    buffer_load_dwordx4 v[252:255], v15, s[12:15], s48 offen offset:0 sc1
    v_mfma_f32_16x16x32_bf16 v[164:167], a[228:231], v[100:103], v[164:167]
    v_mfma_f32_16x16x32_bf16 v[168:171], a[212:215], v[104:107], v[168:171]
    v_mfma_f32_16x16x32_bf16 v[172:175], a[216:219], v[104:107], v[172:175]
    v_mfma_f32_16x16x32_bf16 v[176:179], a[220:223], v[104:107], v[176:179]
    buffer_load_dwordx4 v[16:19], v12, s[12:15], s48 offen offset:1024 sc1
    v_mfma_f32_16x16x32_bf16 v[180:183], a[224:227], v[104:107], v[180:183]
    v_mfma_f32_16x16x32_bf16 v[184:187], a[228:231], v[104:107], v[184:187]
    v_mfma_f32_16x16x32_bf16 v[188:191], a[212:215], v[108:111], v[188:191]
    v_mfma_f32_16x16x32_bf16 v[192:195], a[216:219], v[108:111], v[192:195]
    buffer_load_dwordx4 v[20:23], v13, s[12:15], s48 offen offset:1024 sc1
    v_mfma_f32_16x16x32_bf16 v[196:199], a[220:223], v[108:111], v[196:199]
    v_mfma_f32_16x16x32_bf16 v[200:203], a[224:227], v[108:111], v[200:203]
    v_mfma_f32_16x16x32_bf16 v[204:207], a[228:231], v[108:111], v[204:207]
    s_waitcnt vmcnt(14)
    v_mfma_f32_16x16x32_bf16 v[128:131], a[232:235], v[112:115], v[128:131]
    buffer_load_dwordx4 v[24:27], v14, s[12:15], s48 offen offset:1024 sc1
    v_mfma_f32_16x16x32_bf16 v[132:135], a[236:239], v[112:115], v[132:135]
    v_mfma_f32_16x16x32_bf16 v[136:139], a[240:243], v[112:115], v[136:139]
    v_mfma_f32_16x16x32_bf16 v[140:143], a[244:247], v[112:115], v[140:143]
    v_mfma_f32_16x16x32_bf16 v[144:147], a[248:251], v[112:115], v[144:147]
    buffer_load_dwordx4 v[28:31], v15, s[12:15], s48 offen offset:1024 sc1
    v_mfma_f32_16x16x32_bf16 v[148:151], a[232:235], v[116:119], v[148:151]
    v_mfma_f32_16x16x32_bf16 v[152:155], a[236:239], v[116:119], v[152:155]
    v_mfma_f32_16x16x32_bf16 v[156:159], a[240:243], v[116:119], v[156:159]
    v_mfma_f32_16x16x32_bf16 v[160:163], a[244:247], v[116:119], v[160:163]
    buffer_load_dwordx4 v[32:35], v12, s[12:15], s48 offen offset:2048 sc1
    v_mfma_f32_16x16x32_bf16 v[164:167], a[248:251], v[116:119], v[164:167]
    v_mfma_f32_16x16x32_bf16 v[168:171], a[232:235], v[120:123], v[168:171]
    v_mfma_f32_16x16x32_bf16 v[172:175], a[236:239], v[120:123], v[172:175]
    v_mfma_f32_16x16x32_bf16 v[176:179], a[240:243], v[120:123], v[176:179]
    buffer_load_dwordx4 v[36:39], v13, s[12:15], s48 offen offset:2048 sc1
    v_mfma_f32_16x16x32_bf16 v[180:183], a[244:247], v[120:123], v[180:183]
    v_mfma_f32_16x16x32_bf16 v[184:187], a[248:251], v[120:123], v[184:187]
    v_mfma_f32_16x16x32_bf16 v[188:191], a[232:235], v[124:127], v[188:191]
    v_mfma_f32_16x16x32_bf16 v[192:195], a[236:239], v[124:127], v[192:195]
    buffer_load_dwordx4 v[40:43], v14, s[12:15], s48 offen offset:2048 sc1
    v_mfma_f32_16x16x32_bf16 v[196:199], a[240:243], v[124:127], v[196:199]
    v_mfma_f32_16x16x32_bf16 v[200:203], a[244:247], v[124:127], v[200:203]
    v_mfma_f32_16x16x32_bf16 v[204:207], a[248:251], v[124:127], v[204:207]
    s_waitcnt vmcnt(15)
    v_mfma_f32_16x16x32_bf16 v[128:131], a[0:3], v[208:211], v[128:131]
    buffer_load_dwordx4 v[44:47], v15, s[12:15], s48 offen offset:2048 sc1
    v_mfma_f32_16x16x32_bf16 v[132:135], a[4:7], v[208:211], v[132:135]
    v_mfma_f32_16x16x32_bf16 v[136:139], a[8:11], v[208:211], v[136:139]
    v_mfma_f32_16x16x32_bf16 v[140:143], a[12:15], v[208:211], v[140:143]
    v_mfma_f32_16x16x32_bf16 v[144:147], a[16:19], v[208:211], v[144:147]
    buffer_load_dwordx4 v[48:51], v12, s[12:15], s48 offen offset:3072 sc1
    v_mfma_f32_16x16x32_bf16 v[148:151], a[0:3], v[212:215], v[148:151]
    v_mfma_f32_16x16x32_bf16 v[152:155], a[4:7], v[212:215], v[152:155]
    v_mfma_f32_16x16x32_bf16 v[156:159], a[8:11], v[212:215], v[156:159]
    v_mfma_f32_16x16x32_bf16 v[160:163], a[12:15], v[212:215], v[160:163]
    buffer_load_dwordx4 v[52:55], v13, s[12:15], s48 offen offset:3072 sc1
    v_mfma_f32_16x16x32_bf16 v[164:167], a[16:19], v[212:215], v[164:167]
    v_mfma_f32_16x16x32_bf16 v[168:171], a[0:3], v[216:219], v[168:171]
    v_mfma_f32_16x16x32_bf16 v[172:175], a[4:7], v[216:219], v[172:175]
    v_mfma_f32_16x16x32_bf16 v[176:179], a[8:11], v[216:219], v[176:179]
    buffer_load_dwordx4 v[56:59], v14, s[12:15], s48 offen offset:3072 sc1
    v_mfma_f32_16x16x32_bf16 v[180:183], a[12:15], v[216:219], v[180:183]
    v_mfma_f32_16x16x32_bf16 v[184:187], a[16:19], v[216:219], v[184:187]
    v_mfma_f32_16x16x32_bf16 v[188:191], a[0:3], v[220:223], v[188:191]
    v_mfma_f32_16x16x32_bf16 v[192:195], a[4:7], v[220:223], v[192:195]
    buffer_load_dwordx4 v[60:63], v15, s[12:15], s48 offen offset:3072 sc1
    v_mfma_f32_16x16x32_bf16 v[196:199], a[8:11], v[220:223], v[196:199]
    v_mfma_f32_16x16x32_bf16 v[200:203], a[12:15], v[220:223], v[200:203]
    v_mfma_f32_16x16x32_bf16 v[204:207], a[16:19], v[220:223], v[204:207]
    s_waitcnt vmcnt(16)
    v_mfma_f32_16x16x32_bf16 v[128:131], a[20:23], v[224:227], v[128:131]
    s_add_u32 s48, s48, 4096
    buffer_load_dwordx4 v[64:67], v12, s[12:15], s48 offen offset:0 sc1
    v_mfma_f32_16x16x32_bf16 v[132:135], a[24:27], v[224:227], v[132:135]
    v_mfma_f32_16x16x32_bf16 v[136:139], a[28:31], v[224:227], v[136:139]
    v_mfma_f32_16x16x32_bf16 v[140:143], a[32:35], v[224:227], v[140:143]
    v_mfma_f32_16x16x32_bf16 v[144:147], a[36:39], v[224:227], v[144:147]
    buffer_load_dwordx4 v[68:71], v13, s[12:15], s48 offen offset:0 sc1
    v_mfma_f32_16x16x32_bf16 v[148:151], a[20:23], v[228:231], v[148:151]
    v_mfma_f32_16x16x32_bf16 v[152:155], a[24:27], v[228:231], v[152:155]
    v_mfma_f32_16x16x32_bf16 v[156:159], a[28:31], v[228:231], v[156:159]
    v_mfma_f32_16x16x32_bf16 v[160:163], a[32:35], v[228:231], v[160:163]
    buffer_load_dwordx4 v[72:75], v14, s[12:15], s48 offen offset:0 sc1
    v_mfma_f32_16x16x32_bf16 v[164:167], a[36:39], v[228:231], v[164:167]
    v_mfma_f32_16x16x32_bf16 v[168:171], a[20:23], v[232:235], v[168:171]
    v_mfma_f32_16x16x32_bf16 v[172:175], a[24:27], v[232:235], v[172:175]
    v_mfma_f32_16x16x32_bf16 v[176:179], a[28:31], v[232:235], v[176:179]
    buffer_load_dwordx4 v[76:79], v15, s[12:15], s48 offen offset:0 sc1
    v_mfma_f32_16x16x32_bf16 v[180:183], a[32:35], v[232:235], v[180:183]
    v_mfma_f32_16x16x32_bf16 v[184:187], a[36:39], v[232:235], v[184:187]
    v_mfma_f32_16x16x32_bf16 v[188:191], a[20:23], v[236:239], v[188:191]
    v_mfma_f32_16x16x32_bf16 v[192:195], a[24:27], v[236:239], v[192:195]
    buffer_load_dwordx4 v[80:83], v12, s[12:15], s48 offen offset:1024 sc1
    v_mfma_f32_16x16x32_bf16 v[196:199], a[28:31], v[236:239], v[196:199]
    v_mfma_f32_16x16x32_bf16 v[200:203], a[32:35], v[236:239], v[200:203]
    v_mfma_f32_16x16x32_bf16 v[204:207], a[36:39], v[236:239], v[204:207]
    s_waitcnt vmcnt(17)
    v_mfma_f32_16x16x32_bf16 v[128:131], a[40:43], v[240:243], v[128:131]
    buffer_load_dwordx4 v[84:87], v13, s[12:15], s48 offen offset:1024 sc1
    v_mfma_f32_16x16x32_bf16 v[132:135], a[44:47], v[240:243], v[132:135]
    v_mfma_f32_16x16x32_bf16 v[136:139], a[48:51], v[240:243], v[136:139]
    v_mfma_f32_16x16x32_bf16 v[140:143], a[52:55], v[240:243], v[140:143]
    v_mfma_f32_16x16x32_bf16 v[144:147], a[56:59], v[240:243], v[144:147]
    buffer_load_dwordx4 v[88:91], v14, s[12:15], s48 offen offset:1024 sc1
    v_mfma_f32_16x16x32_bf16 v[148:151], a[40:43], v[244:247], v[148:151]
    v_mfma_f32_16x16x32_bf16 v[152:155], a[44:47], v[244:247], v[152:155]
    v_mfma_f32_16x16x32_bf16 v[156:159], a[48:51], v[244:247], v[156:159]
    v_mfma_f32_16x16x32_bf16 v[160:163], a[52:55], v[244:247], v[160:163]
    buffer_load_dwordx4 v[92:95], v15, s[12:15], s48 offen offset:1024 sc1
    v_mfma_f32_16x16x32_bf16 v[164:167], a[56:59], v[244:247], v[164:167]
    v_mfma_f32_16x16x32_bf16 v[168:171], a[40:43], v[248:251], v[168:171]
    v_mfma_f32_16x16x32_bf16 v[172:175], a[44:47], v[248:251], v[172:175]
    v_mfma_f32_16x16x32_bf16 v[176:179], a[48:51], v[248:251], v[176:179]
    buffer_load_dwordx4 v[96:99], v12, s[12:15], s48 offen offset:2048 sc1
    v_mfma_f32_16x16x32_bf16 v[180:183], a[52:55], v[248:251], v[180:183]
    v_mfma_f32_16x16x32_bf16 v[184:187], a[56:59], v[248:251], v[184:187]
    v_mfma_f32_16x16x32_bf16 v[188:191], a[40:43], v[252:255], v[188:191]
    v_mfma_f32_16x16x32_bf16 v[192:195], a[44:47], v[252:255], v[192:195]
    buffer_load_dwordx4 v[100:103], v13, s[12:15], s48 offen offset:2048 sc1
    v_mfma_f32_16x16x32_bf16 v[196:199], a[48:51], v[252:255], v[196:199]
    v_mfma_f32_16x16x32_bf16 v[200:203], a[52:55], v[252:255], v[200:203]
    v_mfma_f32_16x16x32_bf16 v[204:207], a[56:59], v[252:255], v[204:207]
    s_waitcnt lgkmcnt(0)
    s_barrier
    s_waitcnt vmcnt(18)
    v_mfma_f32_16x16x32_bf16 v[128:131], a[60:63], v[16:19], v[128:131]
    buffer_load_dwordx4 v[104:107], v14, s[12:15], s48 offen offset:2048 sc1
    v_mfma_f32_16x16x32_bf16 v[132:135], a[64:67], v[16:19], v[132:135]
    v_mfma_f32_16x16x32_bf16 v[136:139], a[68:71], v[16:19], v[136:139]
    v_mfma_f32_16x16x32_bf16 v[140:143], a[72:75], v[16:19], v[140:143]
    v_mfma_f32_16x16x32_bf16 v[144:147], a[76:79], v[16:19], v[144:147]
    buffer_load_dwordx4 v[108:111], v15, s[12:15], s48 offen offset:2048 sc1
    v_mfma_f32_16x16x32_bf16 v[148:151], a[60:63], v[20:23], v[148:151]
    v_mfma_f32_16x16x32_bf16 v[152:155], a[64:67], v[20:23], v[152:155]
    v_mfma_f32_16x16x32_bf16 v[156:159], a[68:71], v[20:23], v[156:159]
    v_mfma_f32_16x16x32_bf16 v[160:163], a[72:75], v[20:23], v[160:163]
    buffer_load_dwordx4 v[112:115], v12, s[12:15], s48 offen offset:3072 sc1
    v_mfma_f32_16x16x32_bf16 v[164:167], a[76:79], v[20:23], v[164:167]
    v_mfma_f32_16x16x32_bf16 v[168:171], a[60:63], v[24:27], v[168:171]
    v_mfma_f32_16x16x32_bf16 v[172:175], a[64:67], v[24:27], v[172:175]
    v_mfma_f32_16x16x32_bf16 v[176:179], a[68:71], v[24:27], v[176:179]
    buffer_load_dwordx4 v[116:119], v13, s[12:15], s48 offen offset:3072 sc1
    v_mfma_f32_16x16x32_bf16 v[180:183], a[72:75], v[24:27], v[180:183]
    v_mfma_f32_16x16x32_bf16 v[184:187], a[76:79], v[24:27], v[184:187]
    v_mfma_f32_16x16x32_bf16 v[188:191], a[60:63], v[28:31], v[188:191]
    v_mfma_f32_16x16x32_bf16 v[192:195], a[64:67], v[28:31], v[192:195]
    buffer_load_dwordx4 v[120:123], v14, s[12:15], s48 offen offset:3072 sc1
    v_mfma_f32_16x16x32_bf16 v[196:199], a[68:71], v[28:31], v[196:199]
    v_mfma_f32_16x16x32_bf16 v[200:203], a[72:75], v[28:31], v[200:203]
    v_mfma_f32_16x16x32_bf16 v[204:207], a[76:79], v[28:31], v[204:207]
    s_waitcnt vmcnt(19)
    v_mfma_f32_16x16x32_bf16 v[128:131], a[80:83], v[32:35], v[128:131]
    buffer_load_dwordx4 v[124:127], v15, s[12:15], s48 offen offset:3072 sc1
    v_mfma_f32_16x16x32_bf16 v[132:135], a[84:87], v[32:35], v[132:135]
    v_mfma_f32_16x16x32_bf16 v[136:139], a[88:91], v[32:35], v[136:139]
    v_mfma_f32_16x16x32_bf16 v[140:143], a[92:95], v[32:35], v[140:143]
    v_mfma_f32_16x16x32_bf16 v[144:147], a[96:99], v[32:35], v[144:147]
    s_add_u32 s65, s63, 11
    s_mul_i32 s65, s65, 5120
    buffer_load_dwordx4 a[192:195], v0, s[12:15], s65 offen offset:0 sc1
    v_mfma_f32_16x16x32_bf16 v[148:151], a[80:83], v[36:39], v[148:151]
    v_mfma_f32_16x16x32_bf16 v[152:155], a[84:87], v[36:39], v[152:155]
    v_mfma_f32_16x16x32_bf16 v[156:159], a[88:91], v[36:39], v[156:159]
    v_mfma_f32_16x16x32_bf16 v[160:163], a[92:95], v[36:39], v[160:163]
    buffer_load_dwordx4 a[196:199], v0, s[12:15], s65 offen offset:1024 sc1
    v_mfma_f32_16x16x32_bf16 v[164:167], a[96:99], v[36:39], v[164:167]
    v_mfma_f32_16x16x32_bf16 v[168:171], a[80:83], v[40:43], v[168:171]
    v_mfma_f32_16x16x32_bf16 v[172:175], a[84:87], v[40:43], v[172:175]
    v_mfma_f32_16x16x32_bf16 v[176:179], a[88:91], v[40:43], v[176:179]
    buffer_load_dwordx4 a[200:203], v0, s[12:15], s65 offen offset:2048 sc1
    v_mfma_f32_16x16x32_bf16 v[180:183], a[92:95], v[40:43], v[180:183]
    v_mfma_f32_16x16x32_bf16 v[184:187], a[96:99], v[40:43], v[184:187]
    v_mfma_f32_16x16x32_bf16 v[188:191], a[80:83], v[44:47], v[188:191]
    v_mfma_f32_16x16x32_bf16 v[192:195], a[84:87], v[44:47], v[192:195]
    buffer_load_dwordx4 a[204:207], v0, s[12:15], s65 offen offset:3072 sc1
    v_mfma_f32_16x16x32_bf16 v[196:199], a[88:91], v[44:47], v[196:199]
    v_mfma_f32_16x16x32_bf16 v[200:203], a[92:95], v[44:47], v[200:203]
    v_mfma_f32_16x16x32_bf16 v[204:207], a[96:99], v[44:47], v[204:207]
    s_waitcnt vmcnt(20)
    v_mfma_f32_16x16x32_bf16 v[128:131], a[112:115], v[48:51], v[128:131]
    buffer_load_dwordx4 a[208:211], v1, s[12:15], s65 offen offset:0 sc1
    v_mfma_f32_16x16x32_bf16 v[132:135], a[116:119], v[48:51], v[132:135]
    v_mfma_f32_16x16x32_bf16 v[136:139], a[120:123], v[48:51], v[136:139]
    v_mfma_f32_16x16x32_bf16 v[140:143], a[124:127], v[48:51], v[140:143]
    v_mfma_f32_16x16x32_bf16 v[144:147], a[128:131], v[48:51], v[144:147]
    s_add_u32 s48, s48, 4096
    buffer_load_dwordx4 v[208:211], v12, s[12:15], s48 offen offset:0 sc1
    v_mfma_f32_16x16x32_bf16 v[148:151], a[112:115], v[52:55], v[148:151]
    v_mfma_f32_16x16x32_bf16 v[152:155], a[116:119], v[52:55], v[152:155]
    v_mfma_f32_16x16x32_bf16 v[156:159], a[120:123], v[52:55], v[156:159]
    v_mfma_f32_16x16x32_bf16 v[160:163], a[124:127], v[52:55], v[160:163]
    buffer_load_dwordx4 v[212:215], v13, s[12:15], s48 offen offset:0 sc1
    v_mfma_f32_16x16x32_bf16 v[164:167], a[128:131], v[52:55], v[164:167]
    v_mfma_f32_16x16x32_bf16 v[168:171], a[112:115], v[56:59], v[168:171]
    v_mfma_f32_16x16x32_bf16 v[172:175], a[116:119], v[56:59], v[172:175]
    v_mfma_f32_16x16x32_bf16 v[176:179], a[120:123], v[56:59], v[176:179]
    buffer_load_dwordx4 v[216:219], v14, s[12:15], s48 offen offset:0 sc1
    v_mfma_f32_16x16x32_bf16 v[180:183], a[124:127], v[56:59], v[180:183]
    v_mfma_f32_16x16x32_bf16 v[184:187], a[128:131], v[56:59], v[184:187]
    v_mfma_f32_16x16x32_bf16 v[188:191], a[112:115], v[60:63], v[188:191]
    v_mfma_f32_16x16x32_bf16 v[192:195], a[116:119], v[60:63], v[192:195]
    buffer_load_dwordx4 v[220:223], v15, s[12:15], s48 offen offset:0 sc1
    v_mfma_f32_16x16x32_bf16 v[196:199], a[120:123], v[60:63], v[196:199]
    v_mfma_f32_16x16x32_bf16 v[200:203], a[124:127], v[60:63], v[200:203]
    v_mfma_f32_16x16x32_bf16 v[204:207], a[128:131], v[60:63], v[204:207]
    s_waitcnt vmcnt(21)
    v_mfma_f32_16x16x32_bf16 v[128:131], a[132:135], v[64:67], v[128:131]
    s_add_u32 s65, s63, 12
    s_mul_i32 s65, s65, 5120
    buffer_load_dwordx4 a[212:215], v0, s[12:15], s65 offen offset:0 sc1
    v_mfma_f32_16x16x32_bf16 v[132:135], a[136:139], v[64:67], v[132:135]
    v_mfma_f32_16x16x32_bf16 v[136:139], a[140:143], v[64:67], v[136:139]
    v_mfma_f32_16x16x32_bf16 v[140:143], a[144:147], v[64:67], v[140:143]
    v_mfma_f32_16x16x32_bf16 v[144:147], a[148:151], v[64:67], v[144:147]
    buffer_load_dwordx4 a[216:219], v0, s[12:15], s65 offen offset:1024 sc1
    v_mfma_f32_16x16x32_bf16 v[148:151], a[132:135], v[68:71], v[148:151]
    v_mfma_f32_16x16x32_bf16 v[152:155], a[136:139], v[68:71], v[152:155]
    v_mfma_f32_16x16x32_bf16 v[156:159], a[140:143], v[68:71], v[156:159]
    v_mfma_f32_16x16x32_bf16 v[160:163], a[144:147], v[68:71], v[160:163]
    buffer_load_dwordx4 a[220:223], v0, s[12:15], s65 offen offset:2048 sc1
    v_mfma_f32_16x16x32_bf16 v[164:167], a[148:151], v[68:71], v[164:167]
    v_mfma_f32_16x16x32_bf16 v[168:171], a[132:135], v[72:75], v[168:171]
    v_mfma_f32_16x16x32_bf16 v[172:175], a[136:139], v[72:75], v[172:175]
    v_mfma_f32_16x16x32_bf16 v[176:179], a[140:143], v[72:75], v[176:179]
    buffer_load_dwordx4 a[224:227], v0, s[12:15], s65 offen offset:3072 sc1
    v_mfma_f32_16x16x32_bf16 v[180:183], a[144:147], v[72:75], v[180:183]
    v_mfma_f32_16x16x32_bf16 v[184:187], a[148:151], v[72:75], v[184:187]
    v_mfma_f32_16x16x32_bf16 v[188:191], a[132:135], v[76:79], v[188:191]
    v_mfma_f32_16x16x32_bf16 v[192:195], a[136:139], v[76:79], v[192:195]
    buffer_load_dwordx4 a[228:231], v1, s[12:15], s65 offen offset:0 sc1
    v_mfma_f32_16x16x32_bf16 v[196:199], a[140:143], v[76:79], v[196:199]
    v_mfma_f32_16x16x32_bf16 v[200:203], a[144:147], v[76:79], v[200:203]
    v_mfma_f32_16x16x32_bf16 v[204:207], a[148:151], v[76:79], v[204:207]
    s_waitcnt vmcnt(22)
    v_mfma_f32_16x16x32_bf16 v[128:131], a[152:155], v[80:83], v[128:131]
    s_cmp_lt_u32 s36, 2
    s_cselect_b32 s48, s48, 1073741824
    buffer_load_dwordx4 v[224:227], v12, s[12:15], s48 offen offset:1024 sc1
    v_mfma_f32_16x16x32_bf16 v[132:135], a[156:159], v[80:83], v[132:135]
    v_mfma_f32_16x16x32_bf16 v[136:139], a[160:163], v[80:83], v[136:139]
    v_mfma_f32_16x16x32_bf16 v[140:143], a[164:167], v[80:83], v[140:143]
    v_mfma_f32_16x16x32_bf16 v[144:147], a[168:171], v[80:83], v[144:147]
    buffer_load_dwordx4 v[228:231], v13, s[12:15], s48 offen offset:1024 sc1
    v_mfma_f32_16x16x32_bf16 v[148:151], a[152:155], v[84:87], v[148:151]
    v_mfma_f32_16x16x32_bf16 v[152:155], a[156:159], v[84:87], v[152:155]
    v_mfma_f32_16x16x32_bf16 v[156:159], a[160:163], v[84:87], v[156:159]
    v_mfma_f32_16x16x32_bf16 v[160:163], a[164:167], v[84:87], v[160:163]
    buffer_load_dwordx4 v[232:235], v14, s[12:15], s48 offen offset:1024 sc1
    v_mfma_f32_16x16x32_bf16 v[164:167], a[168:171], v[84:87], v[164:167]
    v_mfma_f32_16x16x32_bf16 v[168:171], a[152:155], v[88:91], v[168:171]
    v_mfma_f32_16x16x32_bf16 v[172:175], a[156:159], v[88:91], v[172:175]
    v_mfma_f32_16x16x32_bf16 v[176:179], a[160:163], v[88:91], v[176:179]
    buffer_load_dwordx4 v[236:239], v15, s[12:15], s48 offen offset:1024 sc1
    v_mfma_f32_16x16x32_bf16 v[180:183], a[164:167], v[88:91], v[180:183]
    v_mfma_f32_16x16x32_bf16 v[184:187], a[168:171], v[88:91], v[184:187]
    v_mfma_f32_16x16x32_bf16 v[188:191], a[152:155], v[92:95], v[188:191]
    v_mfma_f32_16x16x32_bf16 v[192:195], a[156:159], v[92:95], v[192:195]
    s_add_u32 s65, s63, 13
    s_mul_i32 s65, s65, 5120
    s_cmp_lt_u32 s36, 2
    s_cselect_b32 s65, s65, 1073741824
    buffer_load_dwordx4 a[232:235], v0, s[12:15], s65 offen offset:0 sc1
    v_mfma_f32_16x16x32_bf16 v[196:199], a[160:163], v[92:95], v[196:199]
    v_mfma_f32_16x16x32_bf16 v[200:203], a[164:167], v[92:95], v[200:203]
    v_mfma_f32_16x16x32_bf16 v[204:207], a[168:171], v[92:95], v[204:207]
    s_waitcnt vmcnt(23)
    v_mfma_f32_16x16x32_bf16 v[128:131], a[172:175], v[96:99], v[128:131]
    buffer_load_dwordx4 a[236:239], v0, s[12:15], s65 offen offset:1024 sc1
    v_mfma_f32_16x16x32_bf16 v[132:135], a[176:179], v[96:99], v[132:135]
    s_add_u32 s47, s36, 1
    s_and_b32 s47, s47, 3
    s_mul_i32 s47, s47, 15360
    s_add_u32 s47, s47, 0
    v_add_u32 v3, s47, v2
    v_mfma_f32_16x16x32_bf16 v[136:139], a[180:183], v[96:99], v[136:139]
    v_mfma_f32_16x16x32_bf16 v[140:143], a[184:187], v[96:99], v[140:143]
    v_mfma_f32_16x16x32_bf16 v[144:147], a[188:191], v[96:99], v[144:147]
    v_mfma_f32_16x16x32_bf16 v[148:151], a[172:175], v[100:103], v[148:151]
    buffer_load_dwordx4 a[240:243], v0, s[12:15], s65 offen offset:2048 sc1
    s_add_u32 s47, s36, 2
    s_and_b32 s47, s47, 3
    s_mul_i32 s47, s47, 15360
    s_add_u32 s47, s47, 5120
    v_add_u32 v4, s47, v2
    v_mfma_f32_16x16x32_bf16 v[152:155], a[176:179], v[100:103], v[152:155]
    v_mfma_f32_16x16x32_bf16 v[156:159], a[180:183], v[100:103], v[156:159]
    v_mfma_f32_16x16x32_bf16 v[160:163], a[184:187], v[100:103], v[160:163]
    v_mfma_f32_16x16x32_bf16 v[164:167], a[188:191], v[100:103], v[164:167]
    s_add_u32 s47, s36, 3
    s_and_b32 s47, s47, 3
    s_mul_i32 s47, s47, 15360
    s_add_u32 s47, s47, 10240
    v_add_u32 v5, s47, v2
    v_mfma_f32_16x16x32_bf16 v[168:171], a[172:175], v[104:107], v[168:171]
    buffer_load_dwordx4 a[244:247], v0, s[12:15], s65 offen offset:3072 sc1
    v_mfma_f32_16x16x32_bf16 v[172:175], a[176:179], v[104:107], v[172:175]
    v_mfma_f32_16x16x32_bf16 v[176:179], a[180:183], v[104:107], v[176:179]
    v_mfma_f32_16x16x32_bf16 v[180:183], a[184:187], v[104:107], v[180:183]
    s_mul_i32 s47, s36, 15360
    v_add_u32 v6, s47, v2
    v_mfma_f32_16x16x32_bf16 v[184:187], a[188:191], v[104:107], v[184:187]
    v_mfma_f32_16x16x32_bf16 v[188:191], a[172:175], v[108:111], v[188:191]
    buffer_load_dwordx4 a[248:251], v1, s[12:15], s65 offen offset:0 sc1
    v_mfma_f32_16x16x32_bf16 v[192:195], a[176:179], v[108:111], v[192:195]
    v_mfma_f32_16x16x32_bf16 v[196:199], a[180:183], v[108:111], v[196:199]
    v_mfma_f32_16x16x32_bf16 v[200:203], a[184:187], v[108:111], v[200:203]
    v_mfma_f32_16x16x32_bf16 v[204:207], a[188:191], v[108:111], v[204:207]
    s_waitcnt vmcnt(23)
    s_waitcnt vmcnt(18)
    v_mfma_f32_16x16x32_bf16 v[128:131], a[192:195], v[112:115], v[128:131]
    v_mfma_f32_16x16x32_bf16 v[132:135], a[196:199], v[112:115], v[132:135]
    v_bfe_u32 v7, v2, 4, 4
    v_mul_u32_u24 v7, 160, v7
    v_lshrrev_b32 v8, 8, v2
    v_lshl_add_u32 v7, v8, 3, v7
    s_mul_i32 s47, s36, 15360
    v_add_u32 v7, s47, v7
    v_mfma_f32_16x16x32_bf16 v[136:139], a[200:203], v[112:115], v[136:139]
    v_mfma_f32_16x16x32_bf16 v[140:143], a[204:207], v[112:115], v[140:143]
    v_mfma_f32_16x16x32_bf16 v[144:147], a[208:211], v[112:115], v[144:147]
    v_mfma_f32_16x16x32_bf16 v[148:151], a[192:195], v[116:119], v[148:151]
    s_lshl_b32 s47, s56, 2
    s_add_u32 s47, s47, s36
    s_lshl_b32 s47, s47, 7
    s_add_u32 s47, s47, s57
    s_mul_i32 s47, s47, 160
    v_add_u32 v10, s47, v2
    v_mfma_f32_16x16x32_bf16 v[152:155], a[196:199], v[116:119], v[152:155]
    v_mfma_f32_16x16x32_bf16 v[156:159], a[200:203], v[116:119], v[156:159]
    v_mfma_f32_16x16x32_bf16 v[160:163], a[204:207], v[116:119], v[160:163]
    v_mfma_f32_16x16x32_bf16 v[164:167], a[208:211], v[116:119], v[164:167]
    v_add_u32 v8, 0, v2
    v_mul_u32_u24 v8, 6554, v8
    v_lshrrev_b32 v8, 20, v8
    v_mul_u32_u24 v8, 1120, v8
    v_add_u32 v8, v8, v10
    v_mfma_f32_16x16x32_bf16 v[168:171], a[192:195], v[120:123], v[168:171]
    v_mfma_f32_16x16x32_bf16 v[172:175], a[196:199], v[120:123], v[172:175]
    v_mfma_f32_16x16x32_bf16 v[176:179], a[200:203], v[120:123], v[176:179]
    v_mfma_f32_16x16x32_bf16 v[180:183], a[204:207], v[120:123], v[180:183]
    v_add_u32 v9, 1024, v2
    v_mul_u32_u24 v9, 6554, v9
    v_lshrrev_b32 v9, 20, v9
    v_mul_u32_u24 v9, 1120, v9
    v_add_u32 v9, v9, v10
    v_mfma_f32_16x16x32_bf16 v[184:187], a[208:211], v[120:123], v[184:187]
    v_mfma_f32_16x16x32_bf16 v[188:191], a[192:195], v[124:127], v[188:191]
    v_mfma_f32_16x16x32_bf16 v[192:195], a[196:199], v[124:127], v[192:195]
    v_mfma_f32_16x16x32_bf16 v[196:199], a[200:203], v[124:127], v[196:199]
    v_add_u32 v11, 2048, v2
    v_mul_u32_u24 v11, 6554, v11
    v_lshrrev_b32 v11, 20, v11
    v_mul_u32_u24 v11, 1120, v11
    v_add_u32 v11, v11, v10
    v_mov_b32 v10, 1073741824
    v_cmp_gt_u32 vcc, 512, v2
    s_nop 1
    v_cndmask_b32 v11, v10, v11, vcc
    v_mfma_f32_16x16x32_bf16 v[200:203], a[204:207], v[124:127], v[200:203]
    v_mfma_f32_16x16x32_bf16 v[204:207], a[208:211], v[124:127], v[204:207]
    s_waitcnt vmcnt(14)
    s_waitcnt vmcnt(9)
    v_mfma_f32_16x16x32_bf16 v[128:131], a[212:215], v[208:211], v[128:131]
    v_mfma_f32_16x16x32_bf16 v[132:135], a[216:219], v[208:211], v[132:135]
    v_mfma_f32_16x16x32_bf16 v[136:139], a[220:223], v[208:211], v[136:139]
    v_mfma_f32_16x16x32_bf16 v[140:143], a[224:227], v[208:211], v[140:143]
    v_mfma_f32_16x16x32_bf16 v[144:147], a[228:231], v[208:211], v[144:147]
    v_mfma_f32_16x16x32_bf16 v[148:151], a[212:215], v[212:215], v[148:151]
    v_mfma_f32_16x16x32_bf16 v[152:155], a[216:219], v[212:215], v[152:155]
    v_mfma_f32_16x16x32_bf16 v[156:159], a[220:223], v[212:215], v[156:159]
    v_mfma_f32_16x16x32_bf16 v[160:163], a[224:227], v[212:215], v[160:163]
    v_mfma_f32_16x16x32_bf16 v[164:167], a[228:231], v[212:215], v[164:167]
    v_mfma_f32_16x16x32_bf16 v[168:171], a[212:215], v[216:219], v[168:171]
    v_mfma_f32_16x16x32_bf16 v[172:175], a[216:219], v[216:219], v[172:175]
    v_mfma_f32_16x16x32_bf16 v[176:179], a[220:223], v[216:219], v[176:179]
    v_mfma_f32_16x16x32_bf16 v[180:183], a[224:227], v[216:219], v[180:183]
    v_mfma_f32_16x16x32_bf16 v[184:187], a[228:231], v[216:219], v[184:187]
    v_mfma_f32_16x16x32_bf16 v[188:191], a[212:215], v[220:223], v[188:191]
    v_mfma_f32_16x16x32_bf16 v[192:195], a[216:219], v[220:223], v[192:195]
    v_mfma_f32_16x16x32_bf16 v[196:199], a[220:223], v[220:223], v[196:199]
    v_mfma_f32_16x16x32_bf16 v[200:203], a[224:227], v[220:223], v[200:203]
    v_mfma_f32_16x16x32_bf16 v[204:207], a[228:231], v[220:223], v[204:207]
    s_waitcnt vmcnt(5)
    s_waitcnt vmcnt(0)
    s_cmp_ge_u32 s36, 2
    s_cbranch_scc1 L2_skip
    v_mfma_f32_16x16x32_bf16 v[148:151], a[232:235], v[228:231], v[148:151]
    v_mfma_f32_16x16x32_bf16 v[152:155], a[236:239], v[228:231], v[152:155]
    v_mfma_f32_16x16x32_bf16 v[156:159], a[240:243], v[228:231], v[156:159]
    v_mfma_f32_16x16x32_bf16 v[160:163], a[244:247], v[228:231], v[160:163]
    v_mfma_f32_16x16x32_bf16 v[164:167], a[248:251], v[228:231], v[164:167]
    v_mfma_f32_16x16x32_bf16 v[168:171], a[232:235], v[232:235], v[168:171]
    s_nop 2
    ds_write_b128 v3, v[148:151] offset:0
    v_mfma_f32_16x16x32_bf16 v[172:175], a[236:239], v[232:235], v[172:175]
    ds_write_b128 v3, v[152:155] offset:1024
    v_mfma_f32_16x16x32_bf16 v[176:179], a[240:243], v[232:235], v[176:179]
    ds_write_b128 v3, v[156:159] offset:2048
    v_mfma_f32_16x16x32_bf16 v[180:183], a[244:247], v[232:235], v[180:183]
    ds_write_b128 v3, v[160:163] offset:3072
    v_mfma_f32_16x16x32_bf16 v[184:187], a[248:251], v[232:235], v[184:187]
    ds_write_b128 v3, v[164:167] offset:4096
    v_mfma_f32_16x16x32_bf16 v[188:191], a[232:235], v[236:239], v[188:191]
    ds_write_b128 v4, v[168:171] offset:0
    v_mfma_f32_16x16x32_bf16 v[192:195], a[236:239], v[236:239], v[192:195]
    ds_write_b128 v4, v[172:175] offset:1024
    v_mfma_f32_16x16x32_bf16 v[196:199], a[240:243], v[236:239], v[196:199]
    ds_write_b128 v4, v[176:179] offset:2048
    v_mfma_f32_16x16x32_bf16 v[200:203], a[244:247], v[236:239], v[200:203]
    ds_write_b128 v4, v[180:183] offset:3072
    v_mfma_f32_16x16x32_bf16 v[204:207], a[248:251], v[236:239], v[204:207]
    ds_write_b128 v4, v[184:187] offset:4096
    v_mfma_f32_16x16x32_bf16 v[128:131], a[232:235], v[224:227], v[128:131]
    ds_write_b128 v5, v[188:191] offset:0
    v_mfma_f32_16x16x32_bf16 v[132:135], a[236:239], v[224:227], v[132:135]
    ds_write_b128 v5, v[192:195] offset:1024
    v_mfma_f32_16x16x32_bf16 v[136:139], a[240:243], v[224:227], v[136:139]
    ds_write_b128 v5, v[196:199] offset:2048
    v_mfma_f32_16x16x32_bf16 v[140:143], a[244:247], v[224:227], v[140:143]
    ds_write_b128 v5, v[200:203] offset:3072
    v_mfma_f32_16x16x32_bf16 v[144:147], a[248:251], v[224:227], v[144:147]
    ds_write_b128 v5, v[204:207] offset:4096
L2_tail:
R_U:
CH_S0:
    s_cbranch_execz Lwarm2_ret
    s_waitcnt lgkmcnt(0)
    s_barrier
    ds_read_b128 v[148:151], v6 offset:0
    ds_read_b128 v[152:155], v6 offset:5120
    ds_read_b128 v[156:159], v6 offset:10240
    ds_read_b128 v[160:163], v6 offset:1024
    ds_read_b128 v[164:167], v6 offset:6144
    ds_read_b128 v[168:171], v6 offset:11264
    ds_read_b128 v[172:175], v6 offset:2048
    ds_read_b128 v[176:179], v6 offset:7168
CH_S1:
    s_cbranch_execz PD_S1_1
    ds_read_b128 v[180:183], v6 offset:12288
    ds_read_b128 v[184:187], v6 offset:3072
    ds_read_b128 v[188:191], v6 offset:8192
    ds_read_b128 v[192:195], v6 offset:13312
    ds_read_b128 v[196:199], v6 offset:4096
    ds_read_b128 v[200:203], v6 offset:9216
    ds_read_b128 v[204:207], v6 offset:14336
    s_waitcnt lgkmcnt(12)
    v_pk_add_f32 v[128:129], v[128:129], v[148:149]
    v_pk_add_f32 v[130:131], v[130:131], v[150:151]
    v_pk_add_f32 v[128:129], v[128:129], v[152:153]
    v_pk_add_f32 v[130:131], v[130:131], v[154:155]
    v_pk_add_f32 v[128:129], v[128:129], v[156:157]
    v_pk_add_f32 v[130:131], v[130:131], v[158:159]
    v_cvt_pk_bf16_f32 v16, v128, v129
    v_cvt_pk_bf16_f32 v17, v130, v131
PD_S1_1:
    s_cbranch_execz Lwarm2_ret
    ds_write_b64 v7, v[16:17] offset:0
    s_waitcnt lgkmcnt(10)
    v_pk_add_f32 v[132:133], v[132:133], v[160:161]
    v_pk_add_f32 v[134:135], v[134:135], v[162:163]
    v_pk_add_f32 v[132:133], v[132:133], v[164:165]
    v_pk_add_f32 v[134:135], v[134:135], v[166:167]
    v_pk_add_f32 v[132:133], v[132:133], v[168:169]
    v_pk_add_f32 v[134:135], v[134:135], v[170:171]
    v_cvt_pk_bf16_f32 v18, v132, v133
    v_cvt_pk_bf16_f32 v19, v134, v135
    ds_write_b64 v7, v[18:19] offset:32
    s_waitcnt lgkmcnt(8)
    v_pk_add_f32 v[136:137], v[136:137], v[172:173]
    v_pk_add_f32 v[138:139], v[138:139], v[174:175]
    v_pk_add_f32 v[136:137], v[136:137], v[176:177]
    v_pk_add_f32 v[138:139], v[138:139], v[178:179]
CH_S2:
    s_cbranch_execz PD_S2_1
    v_pk_add_f32 v[136:137], v[136:137], v[180:181]
    v_pk_add_f32 v[138:139], v[138:139], v[182:183]
    v_cvt_pk_bf16_f32 v20, v136, v137
    v_cvt_pk_bf16_f32 v21, v138, v139
    ds_write_b64 v7, v[20:21] offset:64
    s_waitcnt lgkmcnt(6)
    v_pk_add_f32 v[140:141], v[140:141], v[184:185]
    v_pk_add_f32 v[142:143], v[142:143], v[186:187]
    v_pk_add_f32 v[140:141], v[140:141], v[188:189]
    v_pk_add_f32 v[142:143], v[142:143], v[190:191]
    v_pk_add_f32 v[140:141], v[140:141], v[192:193]
    v_pk_add_f32 v[142:143], v[142:143], v[194:195]
    v_cvt_pk_bf16_f32 v22, v140, v141
    v_cvt_pk_bf16_f32 v23, v142, v143
    ds_write_b64 v7, v[22:23] offset:96
    s_waitcnt lgkmcnt(4)
    v_pk_add_f32 v[144:145], v[144:145], v[196:197]
PD_S2_1:
    s_cbranch_execz Lwarm2_ret
    v_pk_add_f32 v[146:147], v[146:147], v[198:199]
    v_pk_add_f32 v[144:145], v[144:145], v[200:201]
    v_pk_add_f32 v[146:147], v[146:147], v[202:203]
    v_pk_add_f32 v[144:145], v[144:145], v[204:205]
    v_pk_add_f32 v[146:147], v[146:147], v[206:207]
    v_cvt_pk_bf16_f32 v24, v144, v145
    v_cvt_pk_bf16_f32 v25, v146, v147
    ds_write_b64 v7, v[24:25] offset:128
    ds_read_b128 v[32:35], v6 offset:0
    ds_read_b128 v[36:39], v6 offset:1024
    ds_read_b128 v[40:43], v6 offset:2048
    s_waitcnt lgkmcnt(2)
    buffer_store_dwordx4 v[32:35], v8, s[28:31], 0 offen offset:0
    s_waitcnt lgkmcnt(1)
    buffer_store_dwordx4 v[36:39], v9, s[28:31], 0 offen offset:1024
    s_waitcnt lgkmcnt(0)
    buffer_store_dwordx4 v[40:43], v11, s[28:31], 0 offen offset:2048
CH_S3:
    s_cbranch_execz PD_S3_1
    s_endpgm
L2_skip:
    s_nop 7
    s_nop 7
    ds_write_b128 v3, v[148:151] offset:0
    ds_write_b128 v3, v[152:155] offset:1024
    ds_write_b128 v3, v[156:159] offset:2048
    ds_write_b128 v3, v[160:163] offset:3072
    ds_write_b128 v3, v[164:167] offset:4096
    ds_write_b128 v4, v[168:171] offset:0
    ds_write_b128 v4, v[172:175] offset:1024
    ds_write_b128 v4, v[176:179] offset:2048
    ds_write_b128 v4, v[180:183] offset:3072
    ds_write_b128 v4, v[184:187] offset:4096
    ds_write_b128 v5, v[188:191] offset:0
    ds_write_b128 v5, v[192:195] offset:1024
    ds_write_b128 v5, v[196:199] offset:2048
    ds_write_b128 v5, v[200:203] offset:3072
PD_S3_1:
    s_cbranch_execz Lwarm2_ret
    ds_write_b128 v5, v[204:207] offset:4096
    s_branch L2_tail
L1_end:
    s_endpgm
.section .rodata,"a"
.p2align 6
.amdhsa_kernel parallel_sum__sliding_local_dilated__mixer_channel_mlp__prompt_kernel
  .amdhsa_next_free_vgpr 512
  .amdhsa_next_free_sgpr 102
  .amdhsa_accum_offset 256
  .amdhsa_group_segment_fixed_size 0
  .amdhsa_kernarg_size 88
  .amdhsa_user_sgpr_count 2
  .amdhsa_user_sgpr_kernarg_segment_ptr 1
  .amdhsa_system_sgpr_workgroup_id_x 1
  .amdhsa_float_denorm_mode_32 3
.end_amdhsa_kernel
```
